```python
import torch

def _softmax(x, axis=-1):
    return torch.softmax(x, dim=axis)
def _gelu(x):
    return torch.nn.functional.gelu(x, approximate="tanh")
def _silu(x):
    return torch.nn.functional.silu(x)
def _sigmoid(x):
    return torch.sigmoid(x)
def _layernorm(x, axis=-1, eps=1e-5):
    m = x.mean(dim=axis, keepdim=True)
    v = x.var(dim=axis, keepdim=True, unbiased=False)
    return (x - m) / torch.sqrt(v + eps)
def _scatter_add(tgt, idx, src, axis=0):
    return tgt.clone().index_add_(axis, idx, src)
def _segment_sum(src, seg, n):
    out = torch.zeros((n,) + src.shape[1:], dtype=src.dtype)
    return out.index_add_(0, seg, src)
def _pad(x, pw):
    flat = tuple(v for pair in reversed(pw) for v in pair)
    return torch.nn.functional.pad(x, flat)

kernel_name = 'interleave_layers__ssm_conv_h3__linear_kernel_hedgehog__prompt'

def setup_inputs():

    _w = (lambda a: (lambda t: t.to(torch.bfloat16) if t.is_floating_point() else t)(torch.as_tensor(a)))
    def _A_setup():
        B, S, D = 1, 2048, 512
        ks = 4
        return {
            "q": _w((lambda *s: torch.randn(*s, dtype=torch.bfloat16) * 0.05)(B, S, D)),
            "k": _w((lambda *s: torch.randn(*s, dtype=torch.bfloat16) * 0.8)(B, S, D)),
            "v": _w((lambda *s: torch.randn(*s, dtype=torch.bfloat16) * 0.8)(B, S, D)),
            "shift_k": _w((lambda *s: torch.randn(*s, dtype=torch.bfloat16) * 0.8)(D, ks) * 0.5),
            "ssm_k": _w((lambda *s: torch.randn(*s, dtype=torch.bfloat16) * 0.8)(D, S) * (1.0 / S ** 0.5)),
            "ssm_D": _w((lambda *s: torch.randn(*s, dtype=torch.bfloat16) * 0.8)(D)),
        }
    _A_in = _A_setup()

    def _B_setup():
        B, S, D, H = 1, 2048, 512, 32
        Dh = D // H
        return {
            "x": _w((lambda *s: torch.randn(*s, dtype=torch.bfloat16) * 0.05)(B, S, D)),
            "wqkv": _w((lambda *s: torch.randn(*s, dtype=torch.bfloat16) * 0.4)(D, 3 * D)),
            "w_phi": _w((lambda *s: torch.randn(*s, dtype=torch.bfloat16) * 0.4)(H, Dh, Dh) * (Dh ** -0.5)),
            "wo": _w((lambda *s: torch.randn(*s, dtype=torch.bfloat16) * 0.2)(D, D)),
        }
    _B_in = _B_setup()

    return {
        "A_q": _A_in["q"],
        "A_k": _A_in["k"],
        "A_v": _A_in["v"],
        "A_shift_k": _A_in["shift_k"],
        "A_ssm_k": _A_in["ssm_k"],
        "A_ssm_D": _A_in["ssm_D"],
        "B_x": _B_in["x"],
        "B_wqkv": _B_in["wqkv"],
        "B_w_phi": _B_in["w_phi"],
        "B_wo": _B_in["wo"],
    }

def reference(A_q, A_k, A_v, A_shift_k, A_ssm_k, A_ssm_D, B_x, B_wqkv, B_w_phi, B_wo):
    def _A_ref(q, k, v, shift_k, ssm_k, ssm_D):
        B, S, D = q.shape
        ks = shift_k.shape[-1]
        k_pad = _pad(k, ((0, 0), (ks - 1, 0), (0, 0)))
        k_shift = torch.zeros_like(k)
        for t in range(ks):
            k_shift = k_shift + k_pad[:, t:t + S, :] * shift_k[:, ks - 1 - t][None, None, :]
        kv = k_shift * v
        L = 2 * S
        kv_pad = _pad(kv, ((0, 0), (0, S), (0, 0)))
        kf_pad = _pad(ssm_k, ((0, 0), (0, S)))
        kv_f = (lambda x, axes=(-2,-1): torch.fft.rfft2(x.float(), dim=axes))(kv_pad[:, None, :, :], axes=(1, 2))
        kf_f = (lambda x, axes=(-2,-1): torch.fft.rfft2(x.float(), dim=axes))(kf_pad[:, None, :], axes=(1, 2))
        kf_f = (lambda x, *d: x.permute(*d))(kf_f, 1, 2, 0)
        y_f = kv_f * kf_f[None, :, :, :]
        y = (lambda x, s, axes=(-2,-1): torch.fft.irfft2(x, s=s, dim=axes).to(torch.bfloat16))(y_f, (1, L), axes=(1, 2))[:, 0, :S, :]
        y = y + kv * ssm_D[None, None, :]
        return q * y

    def _B_ref(x, wqkv, w_phi, wo):
        B, S, D = x.shape
        H = 32; Dh = D // H
        qkv = (lambda x, *d: x.permute(*d))((x @ wqkv).reshape(B, S, 3, H, Dh), 2, 0, 3, 1, 4)
        q, k, v = qkv[0], qkv[1], qkv[2]
        pq = torch.einsum("bhsd,hdf->bhsf", q, w_phi)
        pk = torch.einsum("bhsd,hdf->bhsf", k, w_phi)
        phi_q = torch.concatenate([_softmax(pq, axis=-1), _softmax(-pq, axis=-1)], axis=-1)
        phi_k = torch.concatenate([_softmax(pk, axis=-1), _softmax(-pk, axis=-1)], axis=-1)
        kv = torch.einsum("bhsf,bhsd->bhfd", phi_k, v)
        z  = torch.einsum("bhsf->bhf", phi_k)
        num = torch.einsum("bhqf,bhfd->bhqd", phi_q, kv)
        den = torch.einsum("bhqf,bhf->bhq", phi_q, z)[..., None] + 1e-6
        o = num / den
        return (lambda x, *d: x.permute(*d))(o, 0, 2, 1, 3).reshape(B, S, D) @ wo

    x = A_q
    x = x + _A_ref(_layernorm(x, axis=-1), A_k, A_v, A_shift_k, A_ssm_k, A_ssm_D)
    x = x + _B_ref(_layernorm(x, axis=-1), B_wqkv, B_w_phi, B_wo)
    x = x + _A_ref(_layernorm(x, axis=-1), A_k, A_v, A_shift_k, A_ssm_k, A_ssm_D)
    x = x + _B_ref(_layernorm(x, axis=-1), B_wqkv, B_w_phi, B_wo)
    return x
```

```asm
; @launch kernel=k0_kernel grid=(320,1,1) block=(256,1,1) lds=16384
; @launch kernel=k1_kernel grid=(256,1,1) block=(256,1,1) lds=106496
; @launch kernel=kf_kernel grid=(256,1,1) block=(256,1,1) lds=132096
.amdgcn_target "amdgcn-amd-amdhsa--gfx950"
.text
.globl k0_kernel
.p2align 8
.type k0_kernel,@function
k0_kernel:
  s_cmp_ge_u32 s2, 320
  s_cbranch_scc1 K0_end
  s_load_dwordx4 s[4:7], s[0:1], 0
  s_load_dwordx4 s[8:11], s[0:1], 16
  s_load_dwordx4 s[12:15], s[0:1], 56
  s_load_dwordx2 s[16:17], s[0:1], 72
  s_load_dwordx2 s[18:19], s[0:1], 96
  v_lshrrev_b32 v1, 6, v0
  v_and_b32 v2, 63, v0
  s_nop 0
  v_readfirstlane_b32 s3, v1
  s_waitcnt lgkmcnt(0)
  s_mov_b32 s20, s18
  s_and_b32 s21, s19, 0xffff
  s_mov_b32 s22, 26214400
  s_mov_b32 s23, 0x20000
  s_cmp_lt_u32 s2, 64
  s_cbranch_scc1 K0_pack
  s_mov_b32 s24, s4
  s_and_b32 s25, s5, 0xffff
  s_mov_b32 s26, 2097152
  s_mov_b32 s27, 0x20000
  s_mov_b32 s28, s6
  s_and_b32 s29, s7, 0xffff
  s_mov_b32 s30, 2097152
  s_mov_b32 s31, 0x20000
  s_mov_b32 s32, s8
  s_and_b32 s33, s9, 0xffff
  s_mov_b32 s34, 2097152
  s_mov_b32 s35, 0x20000
  s_mov_b32 s36, s10
  s_and_b32 s37, s11, 0xffff
  s_mov_b32 s38, 4096
  s_mov_b32 s39, 0x20000
  s_sub_u32 s40, s2, 64
  s_lshr_b32 s41, s40, 3
  s_and_b32 s42, s40, 7
  v_lshrrev_b32 v3, 3, v0
  v_and_b32 v4, 7, v0
  s_lshl_b32 s43, s41, 16
  s_lshl_b32 s44, s42, 7
  s_add_u32 s43, s43, s44
  v_lshlrev_b32 v5, 11, v3
  v_lshl_add_u32 v5, v4, 4, v5
  v_add_u32 v5, s43, v5
  v_add_u32 v6, 0xfffff400, v5
  v_add_u32 v7, 0xfffff800, v5
  v_add_u32 v8, 0xfffffc00, v5
  s_lshl_b32 s45, s42, 9
  v_lshl_add_u32 v9, v4, 6, s45
  buffer_load_dwordx4 v[16:19], v6, s[28:31], 0 offen
  buffer_load_dwordx4 v[20:23], v7, s[28:31], 0 offen
  buffer_load_dwordx4 v[24:27], v8, s[28:31], 0 offen
  buffer_load_dwordx4 v[28:31], v5, s[28:31], 0 offen
  buffer_load_dwordx4 v[32:35], v5, s[28:31], 0 offen offset:1024
  buffer_load_dwordx4 v[36:39], v5, s[32:35], 0 offen
  buffer_load_dwordx4 v[40:43], v5, s[32:35], 0 offen offset:1024
  buffer_load_dwordx4 v[52:55], v9, s[36:39], 0 offen
  buffer_load_dwordx4 v[56:59], v9, s[36:39], 0 offen offset:16
  buffer_load_dwordx4 v[60:63], v9, s[36:39], 0 offen offset:32
  buffer_load_dwordx4 v[64:67], v9, s[36:39], 0 offen offset:48
  s_add_u32 s48, s18, 20971520
  s_addc_u32 s49, s19, 0
  s_mov_b32 s52, s48
  s_and_b32 s53, s49, 0xffff
  s_mov_b32 s54, 262144
  s_mov_b32 s55, 0x20000
  s_lshl_b32 s46, s40, 10
  v_lshl_add_u32 v10, v0, 2, s46
  v_mov_b32 v11, 0
  buffer_store_dword v11, v10, s[52:55], 0 offen
  v_lshrrev_b32 v12, 2, v3
  v_xor_b32 v13, v12, v4
  v_lshlrev_b32 v13, 4, v13
  v_lshl_add_u32 v13, v4, 10, v13
  v_and_b32 v14, 3, v3
  v_lshl_add_u32 v15, v14, 2, v13
  v_xor_b32 v14, 0x7c, v15
  s_mov_b32 s50, 0x05040100
  s_mov_b32 s51, 0x07060302
  s_mov_b32 s47, 0xffff0000
  s_waitcnt vmcnt(1)
  v_lshlrev_b32 v70, 16, v16
  v_lshlrev_b32 v71, 16, v20
  v_lshlrev_b32 v72, 16, v24
  v_lshlrev_b32 v73, 16, v28
  v_lshlrev_b32 v74, 16, v32
  v_lshlrev_b32 v75, 16, v36
  v_lshlrev_b32 v76, 16, v40
  v_lshlrev_b32 v77, 16, v52
  v_and_b32 v78, s47, v52
  v_lshlrev_b32 v79, 16, v53
  v_and_b32 v80, s47, v53
  v_mul_f32 v81, v70, v80
  v_mul_f32 v82, v71, v80
  v_fmac_f32 v81, v71, v79
  v_fmac_f32 v82, v72, v79
  v_fmac_f32 v81, v72, v78
  v_fmac_f32 v82, v73, v78
  v_fmac_f32 v81, v73, v77
  v_fmac_f32 v82, v74, v77
  v_mul_f32 v81, v81, v75
  v_mul_f32 v82, v82, v76
  v_cvt_pk_bf16_f32 v84, v82, v81
  ds_write_b32 v14, v84 offset:0
  v_and_b32 v70, s47, v16
  v_and_b32 v71, s47, v20
  v_and_b32 v72, s47, v24
  v_and_b32 v73, s47, v28
  v_and_b32 v74, s47, v32
  v_and_b32 v75, s47, v36
  v_and_b32 v76, s47, v40
  v_lshlrev_b32 v77, 16, v54
  v_and_b32 v78, s47, v54
  v_lshlrev_b32 v79, 16, v55
  v_and_b32 v80, s47, v55
  v_mul_f32 v81, v70, v80
  v_mul_f32 v82, v71, v80
  v_fmac_f32 v81, v71, v79
  v_fmac_f32 v82, v72, v79
  v_fmac_f32 v81, v72, v78
  v_fmac_f32 v82, v73, v78
  v_fmac_f32 v81, v73, v77
  v_fmac_f32 v82, v74, v77
  v_mul_f32 v81, v81, v75
  v_mul_f32 v82, v82, v76
  v_cvt_pk_bf16_f32 v85, v82, v81
  ds_write_b32 v14, v85 offset:128
  v_lshlrev_b32 v70, 16, v17
  v_lshlrev_b32 v71, 16, v21
  v_lshlrev_b32 v72, 16, v25
  v_lshlrev_b32 v73, 16, v29
  v_lshlrev_b32 v74, 16, v33
  v_lshlrev_b32 v75, 16, v37
  v_lshlrev_b32 v76, 16, v41
  v_lshlrev_b32 v77, 16, v56
  v_and_b32 v78, s47, v56
  v_lshlrev_b32 v79, 16, v57
  v_and_b32 v80, s47, v57
  v_mul_f32 v81, v70, v80
  v_mul_f32 v82, v71, v80
  v_fmac_f32 v81, v71, v79
  v_fmac_f32 v82, v72, v79
  v_fmac_f32 v81, v72, v78
  v_fmac_f32 v82, v73, v78
  v_fmac_f32 v81, v73, v77
  v_fmac_f32 v82, v74, v77
  v_mul_f32 v81, v81, v75
  v_mul_f32 v82, v82, v76
  v_cvt_pk_bf16_f32 v86, v82, v81
  ds_write_b32 v14, v86 offset:256
  v_and_b32 v70, s47, v17
  v_and_b32 v71, s47, v21
  v_and_b32 v72, s47, v25
  v_and_b32 v73, s47, v29
  v_and_b32 v74, s47, v33
  v_and_b32 v75, s47, v37
  v_and_b32 v76, s47, v41
  v_lshlrev_b32 v77, 16, v58
  v_and_b32 v78, s47, v58
  v_lshlrev_b32 v79, 16, v59
  v_and_b32 v80, s47, v59
  v_mul_f32 v81, v70, v80
  v_mul_f32 v82, v71, v80
  v_fmac_f32 v81, v71, v79
  v_fmac_f32 v82, v72, v79
  v_fmac_f32 v81, v72, v78
  v_fmac_f32 v82, v73, v78
  v_fmac_f32 v81, v73, v77
  v_fmac_f32 v82, v74, v77
  v_mul_f32 v81, v81, v75
  v_mul_f32 v82, v82, v76
  v_cvt_pk_bf16_f32 v87, v82, v81
  ds_write_b32 v14, v87 offset:384
  v_lshlrev_b32 v70, 16, v18
  v_lshlrev_b32 v71, 16, v22
  v_lshlrev_b32 v72, 16, v26
  v_lshlrev_b32 v73, 16, v30
  v_lshlrev_b32 v74, 16, v34
  v_lshlrev_b32 v75, 16, v38
  v_lshlrev_b32 v76, 16, v42
  v_lshlrev_b32 v77, 16, v60
  v_and_b32 v78, s47, v60
  v_lshlrev_b32 v79, 16, v61
  v_and_b32 v80, s47, v61
  v_mul_f32 v81, v70, v80
  v_mul_f32 v82, v71, v80
  v_fmac_f32 v81, v71, v79
  v_fmac_f32 v82, v72, v79
  v_fmac_f32 v81, v72, v78
  v_fmac_f32 v82, v73, v78
  v_fmac_f32 v81, v73, v77
  v_fmac_f32 v82, v74, v77
  v_mul_f32 v81, v81, v75
  v_mul_f32 v82, v82, v76
  v_cvt_pk_bf16_f32 v88, v82, v81
  ds_write_b32 v14, v88 offset:512
  v_and_b32 v70, s47, v18
  v_and_b32 v71, s47, v22
  v_and_b32 v72, s47, v26
  v_and_b32 v73, s47, v30
  v_and_b32 v74, s47, v34
  v_and_b32 v75, s47, v38
  v_and_b32 v76, s47, v42
  v_lshlrev_b32 v77, 16, v62
  v_and_b32 v78, s47, v62
  v_lshlrev_b32 v79, 16, v63
  v_and_b32 v80, s47, v63
  v_mul_f32 v81, v70, v80
  v_mul_f32 v82, v71, v80
  v_fmac_f32 v81, v71, v79
  v_fmac_f32 v82, v72, v79
  v_fmac_f32 v81, v72, v78
  v_fmac_f32 v82, v73, v78
  v_fmac_f32 v81, v73, v77
  v_fmac_f32 v82, v74, v77
  v_mul_f32 v81, v81, v75
  v_mul_f32 v82, v82, v76
  v_cvt_pk_bf16_f32 v89, v82, v81
  ds_write_b32 v14, v89 offset:640
  v_lshlrev_b32 v70, 16, v19
  v_lshlrev_b32 v71, 16, v23
  v_lshlrev_b32 v72, 16, v27
  v_lshlrev_b32 v73, 16, v31
  v_lshlrev_b32 v74, 16, v35
  v_lshlrev_b32 v75, 16, v39
  v_lshlrev_b32 v76, 16, v43
  v_lshlrev_b32 v77, 16, v64
  v_and_b32 v78, s47, v64
  v_lshlrev_b32 v79, 16, v65
  v_and_b32 v80, s47, v65
  v_mul_f32 v81, v70, v80
  v_mul_f32 v82, v71, v80
  v_fmac_f32 v81, v71, v79
  v_fmac_f32 v82, v72, v79
  v_fmac_f32 v81, v72, v78
  v_fmac_f32 v82, v73, v78
  v_fmac_f32 v81, v73, v77
  v_fmac_f32 v82, v74, v77
  v_mul_f32 v81, v81, v75
  v_mul_f32 v82, v82, v76
  v_cvt_pk_bf16_f32 v90, v82, v81
  ds_write_b32 v14, v90 offset:768
  v_and_b32 v70, s47, v19
  v_and_b32 v71, s47, v23
  v_and_b32 v72, s47, v27
  v_and_b32 v73, s47, v31
  v_and_b32 v74, s47, v35
  v_and_b32 v75, s47, v39
  v_and_b32 v76, s47, v43
  v_lshlrev_b32 v77, 16, v66
  v_and_b32 v78, s47, v66
  v_lshlrev_b32 v79, 16, v67
  v_and_b32 v80, s47, v67
  v_mul_f32 v81, v70, v80
  v_mul_f32 v82, v71, v80
  v_fmac_f32 v81, v71, v79
  v_fmac_f32 v82, v72, v79
  v_fmac_f32 v81, v72, v78
  v_fmac_f32 v82, v73, v78
  v_fmac_f32 v81, v73, v77
  v_fmac_f32 v82, v74, v77
  v_mul_f32 v81, v81, v75
  v_mul_f32 v82, v82, v76
  v_cvt_pk_bf16_f32 v91, v82, v81
  ds_write_b32 v14, v91 offset:896
  v_lshrrev_b32 v12, 6, v0
  v_xor_b32 v12, v12, v4
  v_lshlrev_b32 v12, 4, v12
  v_lshl_add_u32 v12, v3, 7, v12
  v_xor_b32 v13, 64, v12
  s_lshl_b32 s43, s42, 18
  s_lshl_b32 s44, s41, 7
  s_add_u32 s45, s43, s44
  s_add_u32 s45, s45, 2097152
  s_sub_u32 s43, s43, s44
  s_add_u32 s43, s43, 3968
  v_lshlrev_b32 v5, 12, v3
  v_lshl_add_u32 v5, v4, 4, v5
  v_add_u32 v6, 0x20000, v5
  s_waitcnt lgkmcnt(0)
  s_barrier
  ds_read_b128 v[16:19], v12
  ds_read_b128 v[20:23], v13 offset:4096
  s_waitcnt lgkmcnt(1)
  buffer_store_dwordx4 v[16:19], v5, s[20:23], s43 offen
  s_waitcnt lgkmcnt(0)
  buffer_store_dwordx4 v[20:23], v6, s[20:23], s43 offen
  s_endpgm
K0_pack:
  s_mov_b32 s24, s12
  s_and_b32 s25, s13, 0xffff
  s_mov_b32 s26, 1572864
  s_mov_b32 s27, 0x20000
  s_mov_b32 s28, s14
  s_and_b32 s29, s15, 0xffff
  s_mov_b32 s30, 16384
  s_mov_b32 s31, 0x20000
  s_mov_b32 s40, s2
  v_and_b32 v3, 31, v0
  v_bfe_u32 v4, v0, 5, 1
  v_and_b32 v5, 0x13, v3
  v_and_b32 v6, 4, v3
  v_lshl_or_b32 v5, v6, 1, v5
  v_and_b32 v6, 8, v3
  v_lshrrev_b32 v6, 1, v6
  v_or_b32 v5, v5, v6
  s_cmp_lt_u32 s40, 48
  s_cbranch_scc1 K0_pq
  s_mov_b32 s24, s16
  s_and_b32 s25, s17, 0xffff
  s_mov_b32 s26, 524288
  s_mov_b32 s27, 0x20000
  s_sub_u32 s41, s40, 48
  s_lshl_b32 s42, s41, 6
  s_movk_i32 s43, 1024
  s_lshl_b32 s44, s41, 15
  s_add_u32 s44, s44, 7340032
  s_movk_i32 s45, 1024
  s_mov_b32 s46, 2
  v_mov_b32 v5, v3
  s_mov_b32 s47, 6823936
  s_branch K0_pgo
K0_pq:
  s_lshr_b32 s46, s40, 4
  s_and_b32 s41, s40, 15
  s_lshl_b32 s42, s41, 6
  s_lshl_b32 s43, s46, 10
  s_add_u32 s42, s42, s43
  s_mul_i32 s44, s41, 98304
  s_add_u32 s44, s44, s43
  s_add_u32 s44, s44, 5242880
  s_movk_i32 s43, 3072
  s_movk_i32 s45, 3072
  s_mul_i32 s47, s41, 384
  s_lshl_b32 s48, s46, 7
  s_add_u32 s47, s47, s48
  s_add_u32 s47, s47, 6815744
K0_pgo:
  v_mul_lo_u32 v7, v5, s43
  v_lshl_add_u32 v7, v4, 4, v7
  s_lshl_b32 s43, s43, 5
  s_lshl_b32 s48, s3, 2
  s_mul_i32 s49, s48, s43
  s_add_u32 s42, s42, s49
  s_lshl_b32 s48, s48, 1
  s_mul_i32 s49, s48, s45
  s_add_u32 s44, s44, s49
  buffer_load_dwordx4 v[64:67], v7, s[24:27], s42 offen
  buffer_load_dwordx4 v[68:71], v7, s[24:27], s42 offen offset:32
  s_add_u32 s42, s42, s43
  buffer_load_dwordx4 v[72:75], v7, s[24:27], s42 offen
  buffer_load_dwordx4 v[76:79], v7, s[24:27], s42 offen offset:32
  s_add_u32 s42, s42, s43
  buffer_load_dwordx4 v[80:83], v7, s[24:27], s42 offen
  buffer_load_dwordx4 v[84:87], v7, s[24:27], s42 offen offset:32
  s_add_u32 s42, s42, s43
  buffer_load_dwordx4 v[88:91], v7, s[24:27], s42 offen
  buffer_load_dwordx4 v[92:95], v7, s[24:27], s42 offen offset:32
  v_and_b32 v8, 15, v0
  v_bfe_u32 v9, v0, 4, 1
  s_cmp_lt_u32 s46, 2
  s_cbranch_scc1 K0_phi
  v_lshlrev_b32 v10, 3, v4
  v_sub_u32 v10, v8, v10
  v_mov_b32 v12, 0x3f80
  v_mov_b32 v13, 0x3f800000
  v_cmp_eq_u32 vcc, 0, v10
  s_nop 1
  v_cndmask_b32 v16, 0, v12, vcc
  v_cmp_eq_u32 vcc, 1, v10
  s_nop 1
  v_cndmask_b32 v16, v16, v13, vcc
  v_cmp_eq_u32 vcc, 2, v10
  s_nop 1
  v_cndmask_b32 v17, 0, v12, vcc
  v_cmp_eq_u32 vcc, 3, v10
  s_nop 1
  v_cndmask_b32 v17, v17, v13, vcc
  v_cmp_eq_u32 vcc, 4, v10
  s_nop 1
  v_cndmask_b32 v18, 0, v12, vcc
  v_cmp_eq_u32 vcc, 5, v10
  s_nop 1
  v_cndmask_b32 v18, v18, v13, vcc
  v_cmp_eq_u32 vcc, 6, v10
  s_nop 1
  v_cndmask_b32 v19, 0, v12, vcc
  v_cmp_eq_u32 vcc, 7, v10
  s_nop 1
  v_cndmask_b32 v19, v19, v13, vcc
  s_branch K0_pb
K0_phi:
  s_lshl_b32 s48, s41, 10
  v_lshlrev_b32 v10, 9, v9
  v_lshl_add_u32 v10, v4, 8, v10
  v_lshl_add_u32 v10, v8, 1, v10
  buffer_load_ushort v32, v10, s[28:31], s48 offen offset:0
  buffer_load_ushort v33, v10, s[28:31], s48 offen offset:32
  buffer_load_ushort v34, v10, s[28:31], s48 offen offset:64
  buffer_load_ushort v35, v10, s[28:31], s48 offen offset:96
  buffer_load_ushort v36, v10, s[28:31], s48 offen offset:128
  buffer_load_ushort v37, v10, s[28:31], s48 offen offset:160
  buffer_load_ushort v38, v10, s[28:31], s48 offen offset:192
  buffer_load_ushort v39, v10, s[28:31], s48 offen offset:224
  s_waitcnt vmcnt(0)
  v_lshl_or_b32 v16, v33, 16, v32
  v_lshl_or_b32 v17, v35, 16, v34
  v_lshl_or_b32 v18, v37, 16, v36
  v_lshl_or_b32 v19, v39, 16, v38
K0_pb:
  v_cmp_eq_u32 vcc, 0, v9
  v_lshlrev_b32 v11, 4, v2
  v_mov_b32 v14, 0
  s_mov_b32 s49, 0x3f803f80
  v_cndmask_b32 v20, 0, v16, vcc
  v_cndmask_b32 v24, v16, 0, vcc
  v_cndmask_b32 v21, 0, v17, vcc
  v_cndmask_b32 v25, v17, 0, vcc
  v_cndmask_b32 v22, 0, v18, vcc
  v_cndmask_b32 v26, v18, 0, vcc
  v_cndmask_b32 v23, 0, v19, vcc
  v_cndmask_b32 v27, v19, 0, vcc
  s_waitcnt vmcnt(0)
  v_mfma_f32_32x32x16_bf16 v[32:47], v[64:67], v[20:23], 0
  v_mfma_f32_32x32x16_bf16 v[32:47], v[68:71], v[24:27], v[32:47]
  v_mfma_f32_32x32x16_bf16 v[48:63], v[72:75], v[20:23], 0
  v_mfma_f32_32x32x16_bf16 v[48:63], v[76:79], v[24:27], v[48:63]
  s_nop 9
  v_cvt_pk_bf16_f32 v64, v32, v33
  v_cvt_pk_bf16_f32 v65, v34, v35
  v_cvt_pk_bf16_f32 v66, v36, v37
  v_cvt_pk_bf16_f32 v67, v38, v39
  v_cvt_pk_bf16_f32 v68, v40, v41
  v_cvt_pk_bf16_f32 v69, v42, v43
  v_cvt_pk_bf16_f32 v70, v44, v45
  v_cvt_pk_bf16_f32 v71, v46, v47
  v_dot2c_f32_bf16 v14, s49, v64
  v_dot2c_f32_bf16 v14, s49, v65
  v_dot2c_f32_bf16 v14, s49, v66
  v_dot2c_f32_bf16 v14, s49, v67
  v_dot2c_f32_bf16 v14, s49, v68
  v_dot2c_f32_bf16 v14, s49, v69
  v_dot2c_f32_bf16 v14, s49, v70
  v_dot2c_f32_bf16 v14, s49, v71
  buffer_store_dwordx4 v[64:67], v11, s[20:23], s44 offen
  s_add_u32 s44, s44, s45
  buffer_store_dwordx4 v[68:71], v11, s[20:23], s44 offen
  s_add_u32 s44, s44, s45
  v_mfma_f32_32x32x16_bf16 v[32:47], v[80:83], v[20:23], 0
  v_mfma_f32_32x32x16_bf16 v[32:47], v[84:87], v[24:27], v[32:47]
  v_cvt_pk_bf16_f32 v72, v48, v49
  v_cvt_pk_bf16_f32 v73, v50, v51
  v_cvt_pk_bf16_f32 v74, v52, v53
  v_cvt_pk_bf16_f32 v75, v54, v55
  v_cvt_pk_bf16_f32 v76, v56, v57
  v_cvt_pk_bf16_f32 v77, v58, v59
  v_cvt_pk_bf16_f32 v78, v60, v61
  v_cvt_pk_bf16_f32 v79, v62, v63
  v_dot2c_f32_bf16 v14, s49, v72
  v_dot2c_f32_bf16 v14, s49, v73
  v_dot2c_f32_bf16 v14, s49, v74
  v_dot2c_f32_bf16 v14, s49, v75
  v_dot2c_f32_bf16 v14, s49, v76
  v_dot2c_f32_bf16 v14, s49, v77
  v_dot2c_f32_bf16 v14, s49, v78
  v_dot2c_f32_bf16 v14, s49, v79
  buffer_store_dwordx4 v[72:75], v11, s[20:23], s44 offen
  s_add_u32 s44, s44, s45
  buffer_store_dwordx4 v[76:79], v11, s[20:23], s44 offen
  s_add_u32 s44, s44, s45
  v_mfma_f32_32x32x16_bf16 v[48:63], v[88:91], v[20:23], 0
  v_mfma_f32_32x32x16_bf16 v[48:63], v[92:95], v[24:27], v[48:63]
  v_cvt_pk_bf16_f32 v80, v32, v33
  v_cvt_pk_bf16_f32 v81, v34, v35
  v_cvt_pk_bf16_f32 v82, v36, v37
  v_cvt_pk_bf16_f32 v83, v38, v39
  v_cvt_pk_bf16_f32 v84, v40, v41
  v_cvt_pk_bf16_f32 v85, v42, v43
  v_cvt_pk_bf16_f32 v86, v44, v45
  v_cvt_pk_bf16_f32 v87, v46, v47
  v_dot2c_f32_bf16 v14, s49, v80
  v_dot2c_f32_bf16 v14, s49, v81
  v_dot2c_f32_bf16 v14, s49, v82
  v_dot2c_f32_bf16 v14, s49, v83
  v_dot2c_f32_bf16 v14, s49, v84
  v_dot2c_f32_bf16 v14, s49, v85
  v_dot2c_f32_bf16 v14, s49, v86
  v_dot2c_f32_bf16 v14, s49, v87
  buffer_store_dwordx4 v[80:83], v11, s[20:23], s44 offen
  s_add_u32 s44, s44, s45
  buffer_store_dwordx4 v[84:87], v11, s[20:23], s44 offen
  s_add_u32 s44, s44, s45
  v_cvt_pk_bf16_f32 v88, v48, v49
  v_cvt_pk_bf16_f32 v89, v50, v51
  v_cvt_pk_bf16_f32 v90, v52, v53
  v_cvt_pk_bf16_f32 v91, v54, v55
  v_cvt_pk_bf16_f32 v92, v56, v57
  v_cvt_pk_bf16_f32 v93, v58, v59
  v_cvt_pk_bf16_f32 v94, v60, v61
  v_cvt_pk_bf16_f32 v95, v62, v63
  v_dot2c_f32_bf16 v14, s49, v88
  v_dot2c_f32_bf16 v14, s49, v89
  v_dot2c_f32_bf16 v14, s49, v90
  v_dot2c_f32_bf16 v14, s49, v91
  v_dot2c_f32_bf16 v14, s49, v92
  v_dot2c_f32_bf16 v14, s49, v93
  v_dot2c_f32_bf16 v14, s49, v94
  v_dot2c_f32_bf16 v14, s49, v95
  buffer_store_dwordx4 v[88:91], v11, s[20:23], s44 offen
  s_add_u32 s44, s44, s45
  buffer_store_dwordx4 v[92:95], v11, s[20:23], s44 offen
  s_add_u32 s44, s44, s45
  v_mov_b32 v15, v14
  v_lshlrev_b32 v3, 2, v3
  s_nop 0
  v_permlane32_swap_b32 v14, v15
  v_add_f32 v14, v14, v15
  s_lshl_b32 s48, s3, 7
  v_add_u32 v15, s48, v3
  ds_write_b32 v15, v14
  s_waitcnt lgkmcnt(0)
  s_barrier
  ds_read2_b32 v[16:17], v3 offset0:0 offset1:32
  ds_read2_b32 v[18:19], v3 offset0:64 offset1:96
  s_waitcnt lgkmcnt(0)
  v_add_f32 v16, v16, v17
  v_add_f32 v18, v18, v19
  v_add_f32 v14, v16, v18
  buffer_store_dword v14, v3, s[20:23], s47 offen
K0_end:
  s_endpgm
.globl k1_kernel
.p2align 8
.type k1_kernel,@function
k1_kernel:
  s_cmp_ge_u32 s2, 256
  s_cbranch_scc1 K1_end
  s_load_dwordx4 s[4:7], s[0:1], 32
  s_load_dwordx2 s[18:19], s[0:1], 96
  s_and_b32 s40, s2, 7
  s_lshl_b32 s40, s40, 5
  s_lshr_b32 s41, s2, 3
  s_add_u32 s40, s40, s41
  v_lshrrev_b32 v1, 6, v0
  v_and_b32 v2, 127, v0
  v_lshrrev_b32 v3, 7, v0
  v_readfirstlane_b32 s3, v1
  s_lshl_b32 s41, s40, 13
  v_lshlrev_b32 v4, 4, v0
  v_lshl_add_u32 v4, v3, 11, v4
  s_waitcnt lgkmcnt(0)
  s_mov_b32 s20, s18
  s_and_b32 s21, s19, 0xffff
  s_mov_b32 s22, 26214400
  s_mov_b32 s23, 0x20000
  s_mov_b32 s24, s4
  s_and_b32 s25, s5, 0xffff
  s_mov_b32 s26, 2097152
  s_mov_b32 s27, 0x20000
  s_lshl_b32 s42, s40, 2
  s_load_dword s43, s[6:7], s42
  v_add_u32 v5, s41, v4
  v_add_u32 v6, -16, v5
  v_cmp_eq_u32 vcc, 0, v2
  s_nop 1
  v_cndmask_b32 v7, v6, -1, vcc
  buffer_load_dwordx4 v[16:19], v7, s[24:27], 0 offen
  buffer_load_dwordx4 v[20:23], v5, s[24:27], 0 offen
  buffer_load_dwordx4 v[24:27], v5, s[24:27], 0 offen offset:2032
  buffer_load_dwordx4 v[28:31], v5, s[24:27], 0 offen offset:2048
  buffer_load_dwordx4 v[32:35], v5, s[20:23], 0 offen
  buffer_load_dwordx4 v[36:39], v5, s[20:23], 0 offen offset:2048
  s_add_u32 s44, s41, 2097152
  s_add_u32 s45, s44, 4096
  s_mov_b32 s46, 4194304
  s_mov_b32 s47, 4202496
  v_lshlrev_b32 v8, 1, v0
  v_lshlrev_b32 v9, 3, v0
  v_mov_b64 v[40:41], 0
  v_mov_b64 v[42:43], 0
  v_bfe_u32 v10, v0, 2, 4
  v_and_b32 v11, 3, v0
  v_min_u32 v11, 2, v11
  v_mul_u32_u24 v10, 4160, v10
  v_lshl_add_u32 v10, v11, 4, v10
  v_add_u32 v10, 39936, v10
  ds_write_b128 v10, v[40:43]
  v_mul_u32_u24 v10, 7680, v3
  v_lshl_add_u32 v11, v2, 4, v10
  ds_write_b128 v11, v[40:43] offset:5120
  v_and_b32 v11, 31, v0
  v_lshl_add_u32 v11, v11, 4, v10
  ds_write_b128 v11, v[40:43] offset:7168
  v_lshrrev_b32 v11, 2, v2
  v_mul_u32_u24 v11, 80, v11
  v_add_u32 v10, v10, v11
  v_and_b32 v11, 3, v0
  v_lshl_add_u32 v10, v11, 4, v10
  v_mul_u32_u24 v12, 33280, v3
  v_lshl_add_u32 v12, v2, 4, v12
  v_add_u32 v12, 39936, v12
  s_waitcnt vmcnt(4)
  v_alignbit_b32 v44, v17, v16, 16
  v_alignbit_b32 v50, v18, v17, 16
  v_mov_b32 v56, v17
  v_alignbit_b32 v45, v18, v17, 16
  v_alignbit_b32 v51, v19, v18, 16
  v_mov_b32 v57, v18
  v_alignbit_b32 v46, v19, v18, 16
  v_alignbit_b32 v52, v20, v19, 16
  v_mov_b32 v58, v19
  v_alignbit_b32 v47, v20, v19, 16
  v_alignbit_b32 v53, v21, v20, 16
  v_mov_b32 v59, v20
  v_alignbit_b32 v48, v21, v20, 16
  v_alignbit_b32 v54, v22, v21, 16
  v_mov_b32 v60, v21
  v_alignbit_b32 v49, v22, v21, 16
  v_alignbit_b32 v55, v23, v22, 16
  v_mov_b32 v61, v22
  ds_write_b128 v12, v[18:21] offset:12528
  ds_write_b128 v12, v[20:23] offset:29168
  ds_write_b128 v12, v[44:47] offset:48
  ds_write_b128 v12, v[46:49] offset:16688
  ds_write_b128 v12, v[50:53] offset:8368
  ds_write_b128 v12, v[52:55] offset:25008
  ds_write_b128 v12, v[56:59] offset:4208
  ds_write_b128 v12, v[58:61] offset:20848
  s_waitcnt vmcnt(2)
  v_alignbit_b32 v62, v25, v24, 16
  v_alignbit_b32 v68, v26, v25, 16
  v_mov_b32 v74, v25
  v_alignbit_b32 v63, v26, v25, 16
  v_alignbit_b32 v69, v27, v26, 16
  v_mov_b32 v75, v26
  v_alignbit_b32 v64, v27, v26, 16
  v_alignbit_b32 v70, v28, v27, 16
  v_mov_b32 v76, v27
  v_alignbit_b32 v65, v28, v27, 16
  v_alignbit_b32 v71, v29, v28, 16
  v_mov_b32 v77, v28
  v_alignbit_b32 v66, v29, v28, 16
  v_alignbit_b32 v72, v30, v29, 16
  v_mov_b32 v78, v29
  v_alignbit_b32 v67, v30, v29, 16
  v_alignbit_b32 v73, v31, v30, 16
  v_mov_b32 v79, v30
  ds_write_b128 v12, v[26:29] offset:14576
  ds_write_b128 v12, v[28:31] offset:31216
  ds_write_b128 v12, v[62:65] offset:2096
  ds_write_b128 v12, v[64:67] offset:18736
  ds_write_b128 v12, v[68:71] offset:10416
  ds_write_b128 v12, v[70:73] offset:27056
  ds_write_b128 v12, v[74:77] offset:6256
  ds_write_b128 v12, v[76:79] offset:22896
  s_waitcnt vmcnt(0)
  ds_write_b128 v10, v[32:35] offset:0
  ds_write_b128 v10, v[36:39] offset:2560
  s_lshr_b32 s48, s3, 1
  s_and_b32 s49, s3, 1
  v_and_b32 v10, 7, v0
  v_mul_u32_u24 v10, 4160, v10
  v_bfe_u32 v11, v0, 3, 3
  v_lshl_add_u32 v10, v11, 4, v10
  v_bfe_u32 v12, v0, 5, 1
  v_mul_u32_u24 v11, 48, v12
  v_sub_u32 v10, v10, v11
  s_mul_i32 s50, s48, 33280
  s_add_u32 s50, s50, 39936
  v_add_u32 v10, s50, v10
  v_and_b32 v11, 31, v0
  v_sub_u32 v11, 31, v11
  v_mul_u32_u24 v11, 80, v11
  v_lshl_add_u32 v11, v12, 4, v11
  s_mul_i32 s50, s48, 7680
  s_add_u32 s50, s50, 0
  s_xor_b32 s51, s49, 1
  s_mul_i32 s52, s51, 2560
  s_add_u32 s52, s52, s50
  v_add_u32 v13, s52, v11
  s_mul_i32 s52, s51, 1280
  s_add_u32 s52, s52, s50
  v_add_u32 v14, s52, v11
  s_lshl_b32 s52, s51, 10
  v_add_u32 v15, s52, v10
  s_waitcnt lgkmcnt(0)
  s_barrier
  ds_read_b128 v[16:19], v13 offset:0
  ds_read_b128 v[20:23], v10 offset:0
  ds_read_b128 v[24:27], v13 offset:32
  ds_read_b128 v[28:31], v10 offset:32
  ds_read_b128 v[32:35], v13 offset:80
  ds_read_b128 v[36:39], v10 offset:64
  ds_read_b128 v[40:43], v13 offset:112
  ds_read_b128 v[44:47], v10 offset:96
  ds_read_b128 v[48:51], v13 offset:160
  ds_read_b128 v[52:55], v10 offset:128
  s_waitcnt lgkmcnt(8)
  v_mfma_f32_32x32x16_bf16 v[64:79], v[16:19], v[20:23], 0
  ds_read_b128 v[16:19], v13 offset:192
  ds_read_b128 v[20:23], v10 offset:160
  s_waitcnt lgkmcnt(8)
  v_mfma_f32_32x32x16_bf16 v[64:79], v[24:27], v[28:31], v[64:79]
  ds_read_b128 v[24:27], v13 offset:240
  ds_read_b128 v[28:31], v10 offset:192
  s_waitcnt lgkmcnt(8)
  v_mfma_f32_32x32x16_bf16 v[64:79], v[32:35], v[36:39], v[64:79]
  ds_read_b128 v[32:35], v13 offset:272
  ds_read_b128 v[36:39], v10 offset:224
  s_waitcnt lgkmcnt(8)
  v_mfma_f32_32x32x16_bf16 v[64:79], v[40:43], v[44:47], v[64:79]
  ds_read_b128 v[40:43], v13 offset:320
  ds_read_b128 v[44:47], v10 offset:256
  s_waitcnt lgkmcnt(8)
  v_mfma_f32_32x32x16_bf16 v[64:79], v[48:51], v[52:55], v[64:79]
  ds_read_b128 v[48:51], v13 offset:352
  ds_read_b128 v[52:55], v10 offset:288
  s_waitcnt lgkmcnt(8)
  v_mfma_f32_32x32x16_bf16 v[64:79], v[16:19], v[20:23], v[64:79]
  ds_read_b128 v[16:19], v13 offset:400
  ds_read_b128 v[20:23], v10 offset:320
  s_waitcnt lgkmcnt(8)
  v_mfma_f32_32x32x16_bf16 v[64:79], v[24:27], v[28:31], v[64:79]
  ds_read_b128 v[24:27], v13 offset:432
  ds_read_b128 v[28:31], v10 offset:352
  s_waitcnt lgkmcnt(8)
  v_mfma_f32_32x32x16_bf16 v[64:79], v[32:35], v[36:39], v[64:79]
  ds_read_b128 v[32:35], v13 offset:480
  ds_read_b128 v[36:39], v10 offset:384
  s_waitcnt lgkmcnt(8)
  v_mfma_f32_32x32x16_bf16 v[64:79], v[40:43], v[44:47], v[64:79]
  ds_read_b128 v[40:43], v13 offset:512
  ds_read_b128 v[44:47], v10 offset:416
  s_waitcnt lgkmcnt(8)
  v_mfma_f32_32x32x16_bf16 v[64:79], v[48:51], v[52:55], v[64:79]
  ds_read_b128 v[48:51], v13 offset:560
  ds_read_b128 v[52:55], v10 offset:448
  s_waitcnt lgkmcnt(8)
  v_mfma_f32_32x32x16_bf16 v[64:79], v[16:19], v[20:23], v[64:79]
  ds_read_b128 v[16:19], v13 offset:592
  ds_read_b128 v[20:23], v10 offset:480
  s_waitcnt lgkmcnt(8)
  v_mfma_f32_32x32x16_bf16 v[64:79], v[24:27], v[28:31], v[64:79]
  ds_read_b128 v[24:27], v13 offset:640
  ds_read_b128 v[28:31], v10 offset:512
  s_waitcnt lgkmcnt(8)
  v_mfma_f32_32x32x16_bf16 v[64:79], v[32:35], v[36:39], v[64:79]
  ds_read_b128 v[32:35], v13 offset:672
  ds_read_b128 v[36:39], v10 offset:544
  s_waitcnt lgkmcnt(8)
  v_mfma_f32_32x32x16_bf16 v[64:79], v[40:43], v[44:47], v[64:79]
  ds_read_b128 v[40:43], v13 offset:720
  ds_read_b128 v[44:47], v10 offset:576
  s_waitcnt lgkmcnt(8)
  v_mfma_f32_32x32x16_bf16 v[64:79], v[48:51], v[52:55], v[64:79]
  ds_read_b128 v[48:51], v13 offset:752
  ds_read_b128 v[52:55], v10 offset:608
  s_waitcnt lgkmcnt(8)
  v_mfma_f32_32x32x16_bf16 v[64:79], v[16:19], v[20:23], v[64:79]
  ds_read_b128 v[16:19], v13 offset:800
  ds_read_b128 v[20:23], v10 offset:640
  s_waitcnt lgkmcnt(8)
  v_mfma_f32_32x32x16_bf16 v[64:79], v[24:27], v[28:31], v[64:79]
  ds_read_b128 v[24:27], v13 offset:832
  ds_read_b128 v[28:31], v10 offset:672
  s_waitcnt lgkmcnt(8)
  v_mfma_f32_32x32x16_bf16 v[64:79], v[32:35], v[36:39], v[64:79]
  ds_read_b128 v[32:35], v13 offset:880
  ds_read_b128 v[36:39], v10 offset:704
  s_waitcnt lgkmcnt(8)
  v_mfma_f32_32x32x16_bf16 v[64:79], v[40:43], v[44:47], v[64:79]
  ds_read_b128 v[40:43], v13 offset:912
  ds_read_b128 v[44:47], v10 offset:736
  s_waitcnt lgkmcnt(8)
  v_mfma_f32_32x32x16_bf16 v[64:79], v[48:51], v[52:55], v[64:79]
  ds_read_b128 v[48:51], v13 offset:960
  ds_read_b128 v[52:55], v10 offset:768
  s_waitcnt lgkmcnt(8)
  v_mfma_f32_32x32x16_bf16 v[64:79], v[16:19], v[20:23], v[64:79]
  ds_read_b128 v[16:19], v13 offset:992
  ds_read_b128 v[20:23], v10 offset:800
  s_waitcnt lgkmcnt(8)
  v_mfma_f32_32x32x16_bf16 v[64:79], v[24:27], v[28:31], v[64:79]
  ds_read_b128 v[24:27], v13 offset:1040
  ds_read_b128 v[28:31], v10 offset:832
  s_waitcnt lgkmcnt(8)
  v_mfma_f32_32x32x16_bf16 v[64:79], v[32:35], v[36:39], v[64:79]
  ds_read_b128 v[32:35], v13 offset:1072
  ds_read_b128 v[36:39], v10 offset:864
  s_waitcnt lgkmcnt(8)
  v_mfma_f32_32x32x16_bf16 v[64:79], v[40:43], v[44:47], v[64:79]
  ds_read_b128 v[40:43], v13 offset:1120
  ds_read_b128 v[44:47], v10 offset:896
  s_waitcnt lgkmcnt(8)
  v_mfma_f32_32x32x16_bf16 v[64:79], v[48:51], v[52:55], v[64:79]
  ds_read_b128 v[48:51], v13 offset:1152
  ds_read_b128 v[52:55], v10 offset:928
  s_waitcnt lgkmcnt(8)
  v_mfma_f32_32x32x16_bf16 v[64:79], v[16:19], v[20:23], v[64:79]
  ds_read_b128 v[16:19], v13 offset:1200
  ds_read_b128 v[20:23], v10 offset:960
  s_waitcnt lgkmcnt(8)
  v_mfma_f32_32x32x16_bf16 v[64:79], v[24:27], v[28:31], v[64:79]
  ds_read_b128 v[24:27], v13 offset:1232
  ds_read_b128 v[28:31], v10 offset:992
  s_waitcnt lgkmcnt(8)
  v_mfma_f32_32x32x16_bf16 v[64:79], v[32:35], v[36:39], v[64:79]
  ds_read_b128 v[32:35], v13 offset:1280
  ds_read_b128 v[36:39], v10 offset:1024
  s_waitcnt lgkmcnt(8)
  v_mfma_f32_32x32x16_bf16 v[64:79], v[40:43], v[44:47], v[64:79]
  ds_read_b128 v[40:43], v13 offset:1312
  ds_read_b128 v[44:47], v10 offset:1056
  s_waitcnt lgkmcnt(8)
  v_mfma_f32_32x32x16_bf16 v[64:79], v[48:51], v[52:55], v[64:79]
  ds_read_b128 v[48:51], v13 offset:1360
  ds_read_b128 v[52:55], v10 offset:1088
  s_waitcnt lgkmcnt(8)
  v_mfma_f32_32x32x16_bf16 v[64:79], v[16:19], v[20:23], v[64:79]
  ds_read_b128 v[16:19], v13 offset:1392
  ds_read_b128 v[20:23], v10 offset:1120
  s_waitcnt lgkmcnt(8)
  v_mfma_f32_32x32x16_bf16 v[64:79], v[24:27], v[28:31], v[64:79]
  ds_read_b128 v[24:27], v13 offset:1440
  ds_read_b128 v[28:31], v10 offset:1152
  s_waitcnt lgkmcnt(8)
  v_mfma_f32_32x32x16_bf16 v[64:79], v[32:35], v[36:39], v[64:79]
  ds_read_b128 v[32:35], v13 offset:1472
  ds_read_b128 v[36:39], v10 offset:1184
  s_waitcnt lgkmcnt(8)
  v_mfma_f32_32x32x16_bf16 v[64:79], v[40:43], v[44:47], v[64:79]
  ds_read_b128 v[40:43], v13 offset:1520
  ds_read_b128 v[44:47], v10 offset:1216
  s_waitcnt lgkmcnt(8)
  v_mfma_f32_32x32x16_bf16 v[64:79], v[48:51], v[52:55], v[64:79]
  ds_read_b128 v[48:51], v13 offset:1552
  ds_read_b128 v[52:55], v10 offset:1248
  s_waitcnt lgkmcnt(8)
  v_mfma_f32_32x32x16_bf16 v[64:79], v[16:19], v[20:23], v[64:79]
  ds_read_b128 v[16:19], v13 offset:1600
  ds_read_b128 v[20:23], v10 offset:1280
  s_waitcnt lgkmcnt(8)
  v_mfma_f32_32x32x16_bf16 v[64:79], v[24:27], v[28:31], v[64:79]
  ds_read_b128 v[24:27], v13 offset:1632
  ds_read_b128 v[28:31], v10 offset:1312
  s_waitcnt lgkmcnt(8)
  v_mfma_f32_32x32x16_bf16 v[64:79], v[32:35], v[36:39], v[64:79]
  ds_read_b128 v[32:35], v13 offset:1680
  ds_read_b128 v[36:39], v10 offset:1344
  s_waitcnt lgkmcnt(8)
  v_mfma_f32_32x32x16_bf16 v[64:79], v[40:43], v[44:47], v[64:79]
  ds_read_b128 v[40:43], v13 offset:1712
  ds_read_b128 v[44:47], v10 offset:1376
  s_waitcnt lgkmcnt(8)
  v_mfma_f32_32x32x16_bf16 v[64:79], v[48:51], v[52:55], v[64:79]
  ds_read_b128 v[48:51], v13 offset:1760
  ds_read_b128 v[52:55], v10 offset:1408
  s_waitcnt lgkmcnt(8)
  v_mfma_f32_32x32x16_bf16 v[64:79], v[16:19], v[20:23], v[64:79]
  ds_read_b128 v[16:19], v13 offset:1792
  ds_read_b128 v[20:23], v10 offset:1440
  s_waitcnt lgkmcnt(8)
  v_mfma_f32_32x32x16_bf16 v[64:79], v[24:27], v[28:31], v[64:79]
  ds_read_b128 v[24:27], v13 offset:1840
  ds_read_b128 v[28:31], v10 offset:1472
  s_waitcnt lgkmcnt(8)
  v_mfma_f32_32x32x16_bf16 v[64:79], v[32:35], v[36:39], v[64:79]
  ds_read_b128 v[32:35], v13 offset:1872
  ds_read_b128 v[36:39], v10 offset:1504
  s_waitcnt lgkmcnt(8)
  v_mfma_f32_32x32x16_bf16 v[64:79], v[40:43], v[44:47], v[64:79]
  ds_read_b128 v[40:43], v13 offset:1920
  ds_read_b128 v[44:47], v10 offset:1536
  s_waitcnt lgkmcnt(8)
  v_mfma_f32_32x32x16_bf16 v[64:79], v[48:51], v[52:55], v[64:79]
  ds_read_b128 v[48:51], v13 offset:1952
  ds_read_b128 v[52:55], v10 offset:1568
  s_waitcnt lgkmcnt(8)
  v_mfma_f32_32x32x16_bf16 v[64:79], v[16:19], v[20:23], v[64:79]
  ds_read_b128 v[16:19], v13 offset:2000
  ds_read_b128 v[20:23], v10 offset:1600
  s_waitcnt lgkmcnt(8)
  v_mfma_f32_32x32x16_bf16 v[64:79], v[24:27], v[28:31], v[64:79]
  ds_read_b128 v[24:27], v13 offset:2032
  ds_read_b128 v[28:31], v10 offset:1632
  s_waitcnt lgkmcnt(8)
  v_mfma_f32_32x32x16_bf16 v[64:79], v[32:35], v[36:39], v[64:79]
  ds_read_b128 v[32:35], v13 offset:2080
  ds_read_b128 v[36:39], v10 offset:1664
  s_waitcnt lgkmcnt(8)
  v_mfma_f32_32x32x16_bf16 v[64:79], v[40:43], v[44:47], v[64:79]
  ds_read_b128 v[40:43], v13 offset:2112
  ds_read_b128 v[44:47], v10 offset:1696
  s_waitcnt lgkmcnt(8)
  v_mfma_f32_32x32x16_bf16 v[64:79], v[48:51], v[52:55], v[64:79]
  ds_read_b128 v[48:51], v13 offset:2160
  ds_read_b128 v[52:55], v10 offset:1728
  s_waitcnt lgkmcnt(8)
  v_mfma_f32_32x32x16_bf16 v[64:79], v[16:19], v[20:23], v[64:79]
  ds_read_b128 v[16:19], v13 offset:2192
  ds_read_b128 v[20:23], v10 offset:1760
  s_waitcnt lgkmcnt(8)
  v_mfma_f32_32x32x16_bf16 v[64:79], v[24:27], v[28:31], v[64:79]
  ds_read_b128 v[24:27], v13 offset:2240
  ds_read_b128 v[28:31], v10 offset:1792
  s_waitcnt lgkmcnt(8)
  v_mfma_f32_32x32x16_bf16 v[64:79], v[32:35], v[36:39], v[64:79]
  ds_read_b128 v[32:35], v13 offset:2272
  ds_read_b128 v[36:39], v10 offset:1824
  s_waitcnt lgkmcnt(8)
  v_mfma_f32_32x32x16_bf16 v[64:79], v[40:43], v[44:47], v[64:79]
  ds_read_b128 v[40:43], v13 offset:2320
  ds_read_b128 v[44:47], v10 offset:1856
  s_waitcnt lgkmcnt(8)
  v_mfma_f32_32x32x16_bf16 v[64:79], v[48:51], v[52:55], v[64:79]
  ds_read_b128 v[48:51], v13 offset:2352
  ds_read_b128 v[52:55], v10 offset:1888
  s_waitcnt lgkmcnt(8)
  v_mfma_f32_32x32x16_bf16 v[64:79], v[16:19], v[20:23], v[64:79]
  ds_read_b128 v[16:19], v13 offset:2400
  ds_read_b128 v[20:23], v10 offset:1920
  s_waitcnt lgkmcnt(8)
  v_mfma_f32_32x32x16_bf16 v[64:79], v[24:27], v[28:31], v[64:79]
  ds_read_b128 v[24:27], v13 offset:2432
  ds_read_b128 v[28:31], v10 offset:1952
  s_waitcnt lgkmcnt(8)
  v_mfma_f32_32x32x16_bf16 v[64:79], v[32:35], v[36:39], v[64:79]
  ds_read_b128 v[32:35], v13 offset:2480
  ds_read_b128 v[36:39], v10 offset:1984
  s_waitcnt lgkmcnt(8)
  v_mfma_f32_32x32x16_bf16 v[64:79], v[40:43], v[44:47], v[64:79]
  ds_read_b128 v[40:43], v13 offset:2512
  ds_read_b128 v[44:47], v10 offset:2016
  s_waitcnt lgkmcnt(8)
  v_mfma_f32_32x32x16_bf16 v[64:79], v[48:51], v[52:55], v[64:79]
  ds_read_b128 v[48:51], v14 offset:2560
  ds_read_b128 v[52:55], v15 offset:2048
  s_waitcnt lgkmcnt(8)
  v_mfma_f32_32x32x16_bf16 v[64:79], v[16:19], v[20:23], v[64:79]
  ds_read_b128 v[16:19], v14 offset:2592
  ds_read_b128 v[20:23], v15 offset:2080
  s_waitcnt lgkmcnt(8)
  v_mfma_f32_32x32x16_bf16 v[64:79], v[24:27], v[28:31], v[64:79]
  ds_read_b128 v[24:27], v14 offset:2640
  ds_read_b128 v[28:31], v15 offset:2112
  s_waitcnt lgkmcnt(8)
  v_mfma_f32_32x32x16_bf16 v[64:79], v[32:35], v[36:39], v[64:79]
  ds_read_b128 v[32:35], v14 offset:2672
  ds_read_b128 v[36:39], v15 offset:2144
  s_waitcnt lgkmcnt(8)
  v_mfma_f32_32x32x16_bf16 v[64:79], v[40:43], v[44:47], v[64:79]
  ds_read_b128 v[40:43], v14 offset:2720
  ds_read_b128 v[44:47], v15 offset:2176
  s_waitcnt lgkmcnt(8)
  v_mfma_f32_32x32x16_bf16 v[80:95], v[48:51], v[52:55], 0
  ds_read_b128 v[48:51], v14 offset:2752
  ds_read_b128 v[52:55], v15 offset:2208
  s_waitcnt lgkmcnt(8)
  v_mfma_f32_32x32x16_bf16 v[80:95], v[16:19], v[20:23], v[80:95]
  ds_read_b128 v[16:19], v14 offset:2800
  ds_read_b128 v[20:23], v15 offset:2240
  s_waitcnt lgkmcnt(8)
  v_mfma_f32_32x32x16_bf16 v[80:95], v[24:27], v[28:31], v[80:95]
  ds_read_b128 v[24:27], v14 offset:2832
  ds_read_b128 v[28:31], v15 offset:2272
  s_waitcnt lgkmcnt(8)
  v_mfma_f32_32x32x16_bf16 v[80:95], v[32:35], v[36:39], v[80:95]
  ds_read_b128 v[32:35], v14 offset:2880
  ds_read_b128 v[36:39], v15 offset:2304
  s_waitcnt lgkmcnt(8)
  v_mfma_f32_32x32x16_bf16 v[80:95], v[40:43], v[44:47], v[80:95]
  ds_read_b128 v[40:43], v14 offset:2912
  ds_read_b128 v[44:47], v15 offset:2336
  s_waitcnt lgkmcnt(8)
  v_mfma_f32_32x32x16_bf16 v[80:95], v[48:51], v[52:55], v[80:95]
  ds_read_b128 v[48:51], v14 offset:2960
  ds_read_b128 v[52:55], v15 offset:2368
  s_waitcnt lgkmcnt(8)
  v_mfma_f32_32x32x16_bf16 v[80:95], v[16:19], v[20:23], v[80:95]
  ds_read_b128 v[16:19], v14 offset:2992
  ds_read_b128 v[20:23], v15 offset:2400
  s_waitcnt lgkmcnt(8)
  v_mfma_f32_32x32x16_bf16 v[80:95], v[24:27], v[28:31], v[80:95]
  ds_read_b128 v[24:27], v14 offset:3040
  ds_read_b128 v[28:31], v15 offset:2432
  s_waitcnt lgkmcnt(8)
  v_mfma_f32_32x32x16_bf16 v[80:95], v[32:35], v[36:39], v[80:95]
  ds_read_b128 v[32:35], v14 offset:3072
  ds_read_b128 v[36:39], v15 offset:2464
  s_waitcnt lgkmcnt(8)
  v_mfma_f32_32x32x16_bf16 v[80:95], v[40:43], v[44:47], v[80:95]
  ds_read_b128 v[40:43], v14 offset:3120
  ds_read_b128 v[44:47], v15 offset:2496
  s_waitcnt lgkmcnt(8)
  v_mfma_f32_32x32x16_bf16 v[80:95], v[48:51], v[52:55], v[80:95]
  ds_read_b128 v[48:51], v14 offset:3152
  ds_read_b128 v[52:55], v15 offset:2528
  s_waitcnt lgkmcnt(8)
  v_mfma_f32_32x32x16_bf16 v[80:95], v[16:19], v[20:23], v[80:95]
  ds_read_b128 v[16:19], v14 offset:3200
  ds_read_b128 v[20:23], v15 offset:2560
  s_waitcnt lgkmcnt(8)
  v_mfma_f32_32x32x16_bf16 v[80:95], v[24:27], v[28:31], v[80:95]
  ds_read_b128 v[24:27], v14 offset:3232
  ds_read_b128 v[28:31], v15 offset:2592
  s_waitcnt lgkmcnt(8)
  v_mfma_f32_32x32x16_bf16 v[80:95], v[32:35], v[36:39], v[80:95]
  ds_read_b128 v[32:35], v14 offset:3280
  ds_read_b128 v[36:39], v15 offset:2624
  s_waitcnt lgkmcnt(8)
  v_mfma_f32_32x32x16_bf16 v[80:95], v[40:43], v[44:47], v[80:95]
  ds_read_b128 v[40:43], v14 offset:3312
  ds_read_b128 v[44:47], v15 offset:2656
  s_waitcnt lgkmcnt(8)
  v_mfma_f32_32x32x16_bf16 v[80:95], v[48:51], v[52:55], v[80:95]
  ds_read_b128 v[48:51], v14 offset:3360
  ds_read_b128 v[52:55], v15 offset:2688
  s_waitcnt lgkmcnt(8)
  v_mfma_f32_32x32x16_bf16 v[80:95], v[16:19], v[20:23], v[80:95]
  ds_read_b128 v[16:19], v14 offset:3392
  ds_read_b128 v[20:23], v15 offset:2720
  s_waitcnt lgkmcnt(8)
  v_mfma_f32_32x32x16_bf16 v[80:95], v[24:27], v[28:31], v[80:95]
  ds_read_b128 v[24:27], v14 offset:3440
  ds_read_b128 v[28:31], v15 offset:2752
  s_waitcnt lgkmcnt(8)
  v_mfma_f32_32x32x16_bf16 v[80:95], v[32:35], v[36:39], v[80:95]
  ds_read_b128 v[32:35], v14 offset:3472
  ds_read_b128 v[36:39], v15 offset:2784
  s_waitcnt lgkmcnt(8)
  v_mfma_f32_32x32x16_bf16 v[80:95], v[40:43], v[44:47], v[80:95]
  ds_read_b128 v[40:43], v14 offset:3520
  ds_read_b128 v[44:47], v15 offset:2816
  s_waitcnt lgkmcnt(8)
  v_mfma_f32_32x32x16_bf16 v[80:95], v[48:51], v[52:55], v[80:95]
  ds_read_b128 v[48:51], v14 offset:3552
  ds_read_b128 v[52:55], v15 offset:2848
  s_waitcnt lgkmcnt(8)
  v_mfma_f32_32x32x16_bf16 v[80:95], v[16:19], v[20:23], v[80:95]
  ds_read_b128 v[16:19], v14 offset:3600
  ds_read_b128 v[20:23], v15 offset:2880
  s_waitcnt lgkmcnt(8)
  v_mfma_f32_32x32x16_bf16 v[80:95], v[24:27], v[28:31], v[80:95]
  ds_read_b128 v[24:27], v14 offset:3632
  ds_read_b128 v[28:31], v15 offset:2912
  s_waitcnt lgkmcnt(8)
  v_mfma_f32_32x32x16_bf16 v[80:95], v[32:35], v[36:39], v[80:95]
  ds_read_b128 v[32:35], v14 offset:3680
  ds_read_b128 v[36:39], v15 offset:2944
  s_waitcnt lgkmcnt(8)
  v_mfma_f32_32x32x16_bf16 v[80:95], v[40:43], v[44:47], v[80:95]
  ds_read_b128 v[40:43], v14 offset:3712
  ds_read_b128 v[44:47], v15 offset:2976
  s_waitcnt lgkmcnt(8)
  v_mfma_f32_32x32x16_bf16 v[80:95], v[48:51], v[52:55], v[80:95]
  ds_read_b128 v[48:51], v14 offset:3760
  ds_read_b128 v[52:55], v15 offset:3008
  s_waitcnt lgkmcnt(8)
  v_mfma_f32_32x32x16_bf16 v[80:95], v[16:19], v[20:23], v[80:95]
  ds_read_b128 v[16:19], v14 offset:3792
  ds_read_b128 v[20:23], v15 offset:3040
  s_waitcnt lgkmcnt(8)
  v_mfma_f32_32x32x16_bf16 v[80:95], v[24:27], v[28:31], v[80:95]
  s_waitcnt lgkmcnt(6)
  v_mfma_f32_32x32x16_bf16 v[80:95], v[32:35], v[36:39], v[80:95]
  s_waitcnt lgkmcnt(4)
  v_mfma_f32_32x32x16_bf16 v[80:95], v[40:43], v[44:47], v[80:95]
  s_waitcnt lgkmcnt(2)
  v_mfma_f32_32x32x16_bf16 v[80:95], v[48:51], v[52:55], v[80:95]
  s_waitcnt lgkmcnt(0)
  v_mfma_f32_32x32x16_bf16 v[80:95], v[16:19], v[20:23], v[80:95]
  v_and_b32 v10, 31, v0
  v_lshlrev_b32 v10, 2, v10
  v_lshl_add_u32 v10, v12, 9, v10
  s_mul_i32 s50, s48, 12288
  s_add_u32 s50, s50, 15360
  v_add_u32 v10, s50, v10
  s_lshl_b32 s52, s51, 12
  v_add_u32 v11, s52, v10
  s_cmp_eq_u32 s49, 0
  s_nop 7
  s_cbranch_scc1 K1_a
  v_pk_add_f32 v[80:81], v[80:81], v[64:65]
  v_pk_add_f32 v[82:83], v[82:83], v[66:67]
  v_pk_add_f32 v[84:85], v[84:85], v[68:69]
  v_pk_add_f32 v[86:87], v[86:87], v[70:71]
  v_pk_add_f32 v[88:89], v[88:89], v[72:73]
  v_pk_add_f32 v[90:91], v[90:91], v[74:75]
  v_pk_add_f32 v[92:93], v[92:93], v[76:77]
  v_pk_add_f32 v[94:95], v[94:95], v[78:79]
  s_branch K1_b
K1_a:
  ds_write_b32 v10, v64 offset:0
  ds_write_b32 v10, v65 offset:128
  ds_write_b32 v10, v66 offset:256
  ds_write_b32 v10, v67 offset:384
  ds_write_b32 v10, v68 offset:1024
  ds_write_b32 v10, v69 offset:1152
  ds_write_b32 v10, v70 offset:1280
  ds_write_b32 v10, v71 offset:1408
  ds_write_b32 v10, v72 offset:2048
  ds_write_b32 v10, v73 offset:2176
  ds_write_b32 v10, v74 offset:2304
  ds_write_b32 v10, v75 offset:2432
  ds_write_b32 v10, v76 offset:3072
  ds_write_b32 v10, v77 offset:3200
  ds_write_b32 v10, v78 offset:3328
  ds_write_b32 v10, v79 offset:3456
K1_b:
  ds_write_b32 v11, v80 offset:4096
  ds_write_b32 v11, v81 offset:4224
  ds_write_b32 v11, v82 offset:4352
  ds_write_b32 v11, v83 offset:4480
  ds_write_b32 v11, v84 offset:5120
  ds_write_b32 v11, v85 offset:5248
  ds_write_b32 v11, v86 offset:5376
  ds_write_b32 v11, v87 offset:5504
  ds_write_b32 v11, v88 offset:6144
  ds_write_b32 v11, v89 offset:6272
  ds_write_b32 v11, v90 offset:6400
  ds_write_b32 v11, v91 offset:6528
  ds_write_b32 v11, v92 offset:7168
  ds_write_b32 v11, v93 offset:7296
  ds_write_b32 v11, v94 offset:7424
  ds_write_b32 v11, v95 offset:7552
  v_lshlrev_b32 v10, 2, v0
  v_sub_u32 v11, 255, v0
  v_lshrrev_b32 v12, 5, v11
  v_mul_u32_u24 v12, 80, v12
  v_and_b32 v11, 31, v11
  v_lshl_add_u32 v11, v11, 1, v12
  s_lshl_b32 s44, s43, 16
  s_and_b32 s45, s43, 0xffff0000
  s_mov_b32 s47, 0xffff0000
  s_lshr_b32 s50, s40, 2
  s_lshl_b32 s50, s50, 15
  s_and_b32 s51, s40, 3
  s_lshl_b32 s51, s51, 2
  s_add_u32 s50, s50, s51
  s_add_u32 s51, s50, 10485760
  s_add_u32 s50, s50, 8388608
  v_lshlrev_b32 v13, 4, v0
  s_waitcnt lgkmcnt(0)
  s_barrier
  ds_read_b32 v16, v10 offset:15360
  ds_read_b32 v17, v10 offset:27648
  ds_read_u16 v48, v11 offset:4480
  ds_read_u16 v49, v11 offset:12160
  ds_read_b32 v18, v10 offset:16384
  ds_read_b32 v19, v10 offset:28672
  ds_read_u16 v50, v11 offset:3840
  ds_read_u16 v51, v11 offset:11520
  s_waitcnt lgkmcnt(0)
  ds_read_b32 v20, v10 offset:17408
  ds_read_b32 v21, v10 offset:29696
  ds_read_u16 v52, v11 offset:3200
  ds_read_u16 v53, v11 offset:10880
  ds_read_b32 v22, v10 offset:18432
  ds_read_b32 v23, v10 offset:30720
  ds_read_u16 v54, v11 offset:2560
  ds_read_u16 v55, v11 offset:10240
  s_waitcnt lgkmcnt(0)
  ds_read_b32 v24, v10 offset:19456
  ds_read_b32 v25, v10 offset:31744
  ds_read_u16 v56, v11 offset:1920
  ds_read_u16 v57, v11 offset:9600
  ds_read_b32 v32, v10 offset:23552
  ds_read_b32 v33, v10 offset:35840
  ds_read_b32 v26, v10 offset:20480
  ds_read_b32 v27, v10 offset:32768
  ds_read_u16 v58, v11 offset:1280
  ds_read_u16 v59, v11 offset:8960
  ds_read_b32 v34, v10 offset:24576
  ds_read_b32 v35, v10 offset:36864
  s_waitcnt lgkmcnt(0)
  ds_read_b32 v28, v10 offset:21504
  ds_read_b32 v29, v10 offset:33792
  ds_read_u16 v60, v11 offset:640
  ds_read_u16 v61, v11 offset:8320
  ds_read_b32 v36, v10 offset:25600
  ds_read_b32 v37, v10 offset:37888
  ds_read_b32 v30, v10 offset:22528
  ds_read_b32 v31, v10 offset:34816
  ds_read_u16 v62, v11 offset:0
  ds_read_u16 v63, v11 offset:7680
  ds_read_b32 v38, v10 offset:26624
  ds_read_b32 v39, v10 offset:38912
  s_waitcnt lgkmcnt(0)
  s_waitcnt vmcnt(0)
  v_lshlrev_b32 v48, 16, v48
  v_lshlrev_b32 v49, 16, v49
  v_fmac_f32 v16, s44, v48
  v_fmac_f32 v17, s45, v49
  v_cvt_pk_bf16_f32 v64, v16, v17
  buffer_store_dword v64, v13, s[20:23], s50 offen
  s_add_u32 s50, s50, 4096
  s_add_u32 s51, s51, 4096
  v_lshlrev_b32 v50, 16, v50
  v_lshlrev_b32 v51, 16, v51
  v_fmac_f32 v18, s44, v50
  v_fmac_f32 v19, s45, v51
  v_cvt_pk_bf16_f32 v65, v18, v19
  buffer_store_dword v65, v13, s[20:23], s50 offen
  s_add_u32 s50, s50, 4096
  s_add_u32 s51, s51, 4096
  v_lshlrev_b32 v52, 16, v52
  v_lshlrev_b32 v53, 16, v53
  v_fmac_f32 v20, s44, v52
  v_fmac_f32 v21, s45, v53
  v_cvt_pk_bf16_f32 v66, v20, v21
  buffer_store_dword v66, v13, s[20:23], s50 offen
  s_add_u32 s50, s50, 4096
  s_add_u32 s51, s51, 4096
  v_lshlrev_b32 v54, 16, v54
  v_lshlrev_b32 v55, 16, v55
  v_fmac_f32 v22, s44, v54
  v_fmac_f32 v23, s45, v55
  v_cvt_pk_bf16_f32 v67, v22, v23
  buffer_store_dword v67, v13, s[20:23], s50 offen
  s_add_u32 s50, s50, 4096
  s_add_u32 s51, s51, 4096
  v_pk_add_f32 v[24:25], v[24:25], v[32:33]
  v_lshlrev_b32 v56, 16, v56
  v_lshlrev_b32 v57, 16, v57
  v_fmac_f32 v24, s44, v56
  v_fmac_f32 v25, s45, v57
  v_cvt_pk_bf16_f32 v68, v24, v25
  buffer_store_dword v68, v13, s[20:23], s50 offen
  s_add_u32 s50, s50, 4096
  s_add_u32 s51, s51, 4096
  v_pk_add_f32 v[26:27], v[26:27], v[34:35]
  v_lshlrev_b32 v58, 16, v58
  v_lshlrev_b32 v59, 16, v59
  v_fmac_f32 v26, s44, v58
  v_fmac_f32 v27, s45, v59
  v_cvt_pk_bf16_f32 v69, v26, v27
  buffer_store_dword v69, v13, s[20:23], s50 offen
  s_add_u32 s50, s50, 4096
  s_add_u32 s51, s51, 4096
  v_pk_add_f32 v[28:29], v[28:29], v[36:37]
  v_lshlrev_b32 v60, 16, v60
  v_lshlrev_b32 v61, 16, v61
  v_fmac_f32 v28, s44, v60
  v_fmac_f32 v29, s45, v61
  v_cvt_pk_bf16_f32 v70, v28, v29
  buffer_store_dword v70, v13, s[20:23], s50 offen
  s_add_u32 s50, s50, 4096
  s_add_u32 s51, s51, 4096
  v_pk_add_f32 v[30:31], v[30:31], v[38:39]
  v_lshlrev_b32 v62, 16, v62
  v_lshlrev_b32 v63, 16, v63
  v_fmac_f32 v30, s44, v62
  v_fmac_f32 v31, s45, v63
  v_cvt_pk_bf16_f32 v71, v30, v31
  buffer_store_dword v71, v13, s[20:23], s50 offen
  s_add_u32 s50, s50, 4096
  s_add_u32 s51, s51, 4096
K1_end:
  s_endpgm
.globl kf_kernel
.p2align 8
.type kf_kernel,@function
kf_kernel:
  s_cmp_ge_u32 s2, 256
s_cbranch_scc1 K31_end
s_load_dwordx2 s[16:17], s[0:1], 80
s_load_dwordx2 s[4:5], s[0:1], 0
  s_load_dwordx2 s[18:19], s[0:1], 96
  s_and_b32 s40, s2, 3
  s_lshl_b32 s40, s40, 2
  s_bfe_u32 s41, s2, 0x20003
  s_add_u32 s40, s40, s41
  s_bfe_u32 s41, s2, 0x10002
  s_lshl_b32 s41, s41, 3
  s_lshr_b32 s42, s2, 5
  s_add_u32 s41, s41, s42
  v_lshrrev_b32 v1, 6, v0
  v_and_b32 v2, 63, v0
  v_and_b32 v3, 31, v0
  v_readfirstlane_b32 s3, v1
  v_bfe_u32 v4, v0, 5, 1
  v_lshlrev_b32 v5, 4, v2
  v_lshlrev_b32 v6, 4, v3
  v_lshl_add_u32 v6, v4, 15, v6
  s_lshl_b32 s43, s40, 2
  s_add_u32 s43, s43, s3
  s_lshl_b32 s44, s43, 9
  s_mul_i32 s45, s41, 98304
  s_mul_i32 s46, s3, 3072
  s_add_u32 s45, s45, s46
  s_add_u32 s45, s45, 5242880
  s_add_u32 s47, s44, 10485760
  s_add_u32 s48, s44, 8388608
  s_add_u32 s49, s44, 14680064
  s_waitcnt lgkmcnt(0)
  s_mov_b32 s20, s18
  s_and_b32 s21, s19, 0xffff
  s_mov_b32 s22, 26214400
  s_mov_b32 s23, 0x20000
  s_mov_b32 s24, s4
  s_and_b32 s25, s5, 0xffff
  s_mov_b32 s26, 2097152
  s_mov_b32 s27, 0x20000
  s_lshl_b32 s48, s40, 4
  s_add_u32 s48, s48, s41
  s_lshl_b32 s49, s48, 13
  s_lshl_b32 s48, s48, 7
  s_add_u32 s52, s48, 8388608
  s_add_u32 s53, s48, 9437184
  s_add_u32 s54, s48, 10485760
  s_add_u32 s55, s48, 11534336
  v_and_b32 v8, 7, v0
  v_lshrrev_b32 v9, 3, v0
  v_lshlrev_b32 v10, 10, v8
  v_lshl_add_u32 v10, v9, 4, v10
  v_lshlrev_b32 v11, 15, v9
  v_lshl_add_u32 v11, v8, 4, v11
  buffer_load_dwordx4 v[16:19], v10, s[24:27], s49 offen
  buffer_load_dwordx4 v[20:23], v10, s[24:27], s49 offen offset:512
  buffer_load_dwordx4 v[24:27], v11, s[20:23], s52 offen
  buffer_load_dwordx4 v[28:31], v11, s[20:23], s53 offen
  s_mov_b32 m0, s46
  s_nop 0
  buffer_load_dwordx4 v5, s[20:23], s45 offen lds
  buffer_load_dwordx4 v5, s[20:23], s45 offen offset:1024 lds
  buffer_load_dwordx4 v5, s[20:23], s45 offen offset:2048 lds
  s_add_u32 s45, s45, 12288
  s_add_u32 s46, s46, 12288
  s_mov_b32 m0, s46
  s_nop 0
  buffer_load_dwordx4 v5, s[20:23], s45 offen lds
  buffer_load_dwordx4 v5, s[20:23], s45 offen offset:1024 lds
  buffer_load_dwordx4 v5, s[20:23], s45 offen offset:2048 lds
  s_add_u32 s45, s45, 12288
  s_add_u32 s46, s46, 12288
  s_mov_b32 m0, s46
  s_nop 0
  buffer_load_dwordx4 v5, s[20:23], s45 offen lds
  buffer_load_dwordx4 v5, s[20:23], s45 offen offset:1024 lds
  buffer_load_dwordx4 v5, s[20:23], s45 offen offset:2048 lds
  s_add_u32 s45, s45, 12288
  s_add_u32 s46, s46, 12288
  s_mul_i32 s50, s41, 384
  s_add_u32 s50, s50, 6815744
  v_lshlrev_b32 v7, 4, v4
  s_mov_b32 s53, 0xffff0000
  v_lshlrev_b32 v8, 5, v8
  v_add_u32 v8, 98304, v8
  s_lshl_b32 s48, s3, 3
  v_add_u32 v9, s48, v8
  s_waitcnt vmcnt(11)
  v_lshlrev_b32 v32, 16, v16
  v_and_b32 v33, s53, v16
  v_lshlrev_b32 v34, 16, v17
  v_and_b32 v35, s53, v17
  v_lshlrev_b32 v36, 16, v18
  v_and_b32 v37, s53, v18
  v_lshlrev_b32 v38, 16, v19
  v_and_b32 v39, s53, v19
  v_lshlrev_b32 v40, 16, v20
  v_and_b32 v41, s53, v20
  v_lshlrev_b32 v42, 16, v21
  v_and_b32 v43, s53, v21
  v_lshlrev_b32 v44, 16, v22
  v_and_b32 v45, s53, v22
  v_lshlrev_b32 v46, 16, v23
  v_and_b32 v47, s53, v23
  v_pk_add_f32 v[12:13], v[32:33], v[34:35]
  v_pk_mul_f32 v[14:15], v[32:33], v[32:33]
  v_pk_fma_f32 v[14:15], v[34:35], v[34:35], v[14:15]
  v_pk_add_f32 v[12:13], v[12:13], v[36:37]
  v_pk_fma_f32 v[14:15], v[36:37], v[36:37], v[14:15]
  v_pk_add_f32 v[12:13], v[12:13], v[38:39]
  v_pk_fma_f32 v[14:15], v[38:39], v[38:39], v[14:15]
  v_pk_add_f32 v[12:13], v[12:13], v[40:41]
  v_pk_fma_f32 v[14:15], v[40:41], v[40:41], v[14:15]
  v_pk_add_f32 v[12:13], v[12:13], v[42:43]
  v_pk_fma_f32 v[14:15], v[42:43], v[42:43], v[14:15]
  v_pk_add_f32 v[12:13], v[12:13], v[44:45]
  v_pk_fma_f32 v[14:15], v[44:45], v[44:45], v[14:15]
  v_pk_add_f32 v[12:13], v[12:13], v[46:47]
  v_pk_fma_f32 v[14:15], v[46:47], v[46:47], v[14:15]
  v_add_f32 v12, v12, v13
  v_add_f32 v13, v14, v15
  s_nop 0
  v_add_f32_dpp v14, v12, v12 row_ror:8 row_mask:0xf bank_mask:0xf
  v_add_f32_dpp v15, v13, v13 row_ror:8 row_mask:0xf bank_mask:0xf
  s_nop 1
  v_permlane16_swap_b32 v14, v15
  v_add_f32 v12, v14, v15
  v_mov_b32 v13, v12
  s_nop 1
  v_permlane16_swap_b32 v12, v13
  s_nop 1
  v_permlane32_swap_b32 v12, v13
  v_add_f32 v14, v12, v13
  v_mov_b32 v15, v14
  s_nop 1
  v_permlane32_swap_b32 v14, v15
  ds_write_b64 v9, v[14:15]
  s_waitcnt lgkmcnt(0)
  s_barrier
  ds_read_b128 v[64:67], v8
  ds_read_b128 v[68:71], v8 offset:16
  s_waitcnt vmcnt(9)
  v_lshlrev_b32 v48, 16, v24
  v_and_b32 v49, s53, v24
  v_lshlrev_b32 v50, 16, v25
  v_and_b32 v51, s53, v25
  v_lshlrev_b32 v52, 16, v26
  v_and_b32 v53, s53, v26
  v_lshlrev_b32 v54, 16, v27
  v_and_b32 v55, s53, v27
  v_lshlrev_b32 v56, 16, v28
  v_and_b32 v57, s53, v28
  v_lshlrev_b32 v58, 16, v29
  v_and_b32 v59, s53, v29
  v_lshlrev_b32 v60, 16, v30
  v_and_b32 v61, s53, v30
  v_lshlrev_b32 v62, 16, v31
  v_and_b32 v63, s53, v31
  s_waitcnt lgkmcnt(0)
  v_pk_add_f32 v[64:65], v[64:65], v[66:67]
  v_pk_add_f32 v[68:69], v[68:69], v[70:71]
  v_pk_add_f32 v[14:15], v[64:65], v[68:69]
  v_mul_f32 v12, 0xbb000000, v14
  v_mul_f32 v15, 0x3b000000, v15
  v_fma_f32 v15, -v12, v12, v15
  v_max_f32 v15, 0, v15
  v_add_f32 v15, 0x3727c5ac, v15
  v_rsq_f32 v14, v15
  v_pk_add_f32 v[64:65], v[32:33], v[12:13] op_sel_hi:[1,0]
  v_pk_add_f32 v[66:67], v[34:35], v[12:13] op_sel_hi:[1,0]
  v_pk_add_f32 v[68:69], v[36:37], v[12:13] op_sel_hi:[1,0]
  v_pk_add_f32 v[70:71], v[38:39], v[12:13] op_sel_hi:[1,0]
  v_pk_add_f32 v[72:73], v[40:41], v[12:13] op_sel_hi:[1,0]
  v_pk_add_f32 v[74:75], v[42:43], v[12:13] op_sel_hi:[1,0]
  v_pk_add_f32 v[76:77], v[44:45], v[12:13] op_sel_hi:[1,0]
  v_pk_add_f32 v[78:79], v[46:47], v[12:13] op_sel_hi:[1,0]
  v_pk_mul_f32 v[48:49], v[48:49], v[14:15] op_sel_hi:[1,0]
  v_pk_mul_f32 v[50:51], v[50:51], v[14:15] op_sel_hi:[1,0]
  v_pk_mul_f32 v[52:53], v[52:53], v[14:15] op_sel_hi:[1,0]
  v_pk_mul_f32 v[54:55], v[54:55], v[14:15] op_sel_hi:[1,0]
  v_pk_mul_f32 v[56:57], v[56:57], v[14:15] op_sel_hi:[1,0]
  v_pk_mul_f32 v[58:59], v[58:59], v[14:15] op_sel_hi:[1,0]
  v_pk_mul_f32 v[60:61], v[60:61], v[14:15] op_sel_hi:[1,0]
  v_pk_mul_f32 v[62:63], v[62:63], v[14:15] op_sel_hi:[1,0]
  v_pk_fma_f32 v[32:33], v[64:65], v[48:49], v[32:33]
  v_pk_fma_f32 v[34:35], v[66:67], v[50:51], v[34:35]
  v_pk_fma_f32 v[36:37], v[68:69], v[52:53], v[36:37]
  v_pk_fma_f32 v[38:39], v[70:71], v[54:55], v[38:39]
  v_pk_fma_f32 v[40:41], v[72:73], v[56:57], v[40:41]
  v_pk_fma_f32 v[42:43], v[74:75], v[58:59], v[42:43]
  v_pk_fma_f32 v[44:45], v[76:77], v[60:61], v[44:45]
  v_pk_fma_f32 v[46:47], v[78:79], v[62:63], v[46:47]
  v_cvt_pk_bf16_f32 v16, v32, v33
  v_cvt_pk_bf16_f32 v17, v34, v35
  v_cvt_pk_bf16_f32 v18, v36, v37
  v_cvt_pk_bf16_f32 v19, v38, v39
  v_cvt_pk_bf16_f32 v20, v40, v41
  v_cvt_pk_bf16_f32 v21, v42, v43
  v_cvt_pk_bf16_f32 v22, v44, v45
  v_cvt_pk_bf16_f32 v23, v46, v47
  buffer_store_dwordx4 v[16:19], v11, s[20:23], s54 offen sc0 sc1
  buffer_store_dwordx4 v[20:23], v11, s[20:23], s55 offen sc0 sc1
  s_waitcnt vmcnt(0) lgkmcnt(0)
  s_barrier
  s_cmp_lg_u32 s3, 0
  s_cbranch_scc1 BAR3_m
  v_mov_b32 v1, 1
  v_lshlrev_b32 v2, 6, v0
  v_lshlrev_b32 v3, 10, v0
  s_lshl_b32 s40, s40, 10
  s_lshl_b32 s41, s41, 6
  s_add_u32 s40, s40, s41
  s_add_u32 s40, s40, 21192704
  s_and_b32 s43, s2, 3
  s_lshl_b32 s43, s43, 2
  s_bfe_u32 s42, s2, 0x20003
  s_add_u32 s43, s43, s42
  s_lshl_b32 s41, s43, 10
  s_add_u32 s41, s41, 21192704
  s_mov_b64 exec, 1
  buffer_store_dword v1, v2, s[20:23], s40 offen sc0 sc1
  s_mov_b64 exec, 0xffff
  s_mov_b64 exec, -1
BAR3_m:
  s_mov_b32 m0, s46
  s_nop 0
  buffer_load_dwordx4 v5, s[20:23], s45 offen lds
  buffer_load_dwordx4 v5, s[20:23], s45 offen offset:1024 lds
  buffer_load_dwordx4 v5, s[20:23], s45 offen offset:2048 lds
  s_add_u32 s45, s45, 12288
  s_add_u32 s46, s46, 12288
  s_mov_b32 m0, s46
  s_nop 0
  buffer_load_dwordx4 v5, s[20:23], s45 offen lds
  buffer_load_dwordx4 v5, s[20:23], s45 offen offset:1024 lds
  buffer_load_dwordx4 v5, s[20:23], s45 offen offset:2048 lds
  s_add_u32 s45, s45, 12288
  s_add_u32 s46, s46, 12288
  s_mov_b32 m0, s46
  s_nop 0
  buffer_load_dwordx4 v5, s[20:23], s45 offen lds
  buffer_load_dwordx4 v5, s[20:23], s45 offen offset:1024 lds
  buffer_load_dwordx4 v5, s[20:23], s45 offen offset:2048 lds
  s_add_u32 s45, s45, 12288
  s_add_u32 s46, s46, 12288
  s_mov_b32 m0, s46
  s_nop 0
  buffer_load_dwordx4 v5, s[20:23], s45 offen lds
  buffer_load_dwordx4 v5, s[20:23], s45 offen offset:1024 lds
  buffer_load_dwordx4 v5, s[20:23], s45 offen offset:2048 lds
  s_add_u32 s45, s45, 12288
  s_add_u32 s46, s46, 12288
  s_mov_b32 m0, s46
  s_nop 0
  buffer_load_dwordx4 v5, s[20:23], s45 offen lds
  buffer_load_dwordx4 v5, s[20:23], s45 offen offset:1024 lds
  buffer_load_dwordx4 v5, s[20:23], s45 offen offset:2048 lds
  s_add_u32 s45, s45, 12288
  s_add_u32 s46, s46, 12288
  buffer_load_dwordx4 a[128:131], v7, s[20:23], s50 offen offset:0
  buffer_load_dwordx4 a[132:135], v7, s[20:23], s50 offen offset:32
  buffer_load_dwordx4 a[136:139], v7, s[20:23], s50 offen offset:64
  buffer_load_dwordx4 a[140:143], v7, s[20:23], s50 offen offset:96
  buffer_load_dwordx4 a[144:147], v7, s[20:23], s50 offen offset:128
  buffer_load_dwordx4 a[148:151], v7, s[20:23], s50 offen offset:160
  buffer_load_dwordx4 a[152:155], v7, s[20:23], s50 offen offset:192
  buffer_load_dwordx4 a[156:159], v7, s[20:23], s50 offen offset:224
  buffer_load_dwordx4 a[160:163], v7, s[20:23], s50 offen offset:256
  buffer_load_dwordx4 a[164:167], v7, s[20:23], s50 offen offset:288
  buffer_load_dwordx4 a[168:171], v7, s[20:23], s50 offen offset:320
  buffer_load_dwordx4 a[172:175], v7, s[20:23], s50 offen offset:352
  s_cmp_lg_u32 s3, 0
  s_cbranch_scc1 BAR3_w
  s_mov_b64 exec, 0xffff
  s_mov_b32 s42, 0
BAR3_p:
  buffer_load_dword v4, v2, s[20:23], s41 offen sc0 sc1
  s_add_u32 s42, s42, 1
  s_waitcnt vmcnt(0)
  v_cmp_eq_u32 vcc, 0, v4
  s_cbranch_vccz BAR3_pd
  s_cmp_lt_u32 s42, 0x20000
  s_cbranch_scc1 BAR3_p
BAR3_pd:
  s_mov_b64 exec, -1
BAR3_w:
  s_waitcnt vmcnt(0)
  s_barrier
  s_and_b32 s40, s2, 3
  s_lshl_b32 s40, s40, 2
  s_bfe_u32 s41, s2, 0x20003
  s_add_u32 s40, s40, s41
  s_bfe_u32 s41, s2, 0x10002
  s_lshl_b32 s41, s41, 3
  s_lshr_b32 s42, s2, 5
  s_add_u32 s41, s41, s42
  v_lshrrev_b32 v1, 6, v0
  v_and_b32 v2, 63, v0
  v_and_b32 v3, 31, v0
  v_readfirstlane_b32 s3, v1
  v_bfe_u32 v4, v0, 5, 1
  v_lshlrev_b32 v5, 4, v2
  v_lshlrev_b32 v6, 4, v3
  v_lshl_add_u32 v6, v4, 15, v6
  s_lshl_b32 s43, s40, 2
  s_add_u32 s43, s43, s3
  s_lshl_b32 s44, s43, 9
  s_mul_i32 s45, s41, 98304
  s_mul_i32 s46, s3, 3072
  s_add_u32 s45, s45, s46
  s_add_u32 s45, s45, 5242880
  s_add_u32 s47, s44, 10485760
  s_add_u32 s48, s44, 8388608
  s_add_u32 s49, s44, 14680064
  s_waitcnt lgkmcnt(0)
  s_mov_b32 s20, s18
  s_and_b32 s21, s19, 0xffff
  s_mov_b32 s22, 26214400
  s_mov_b32 s23, 0x20000
  buffer_load_dwordx4 v[128:131], v6, s[20:23], s47 offen
  s_add_u32 s47, s47, 65536
  buffer_load_dwordx4 v[132:135], v6, s[20:23], s47 offen
  s_add_u32 s47, s47, 65536
  buffer_load_dwordx4 v[136:139], v6, s[20:23], s47 offen
  s_add_u32 s47, s47, 65536
  buffer_load_dwordx4 v[140:143], v6, s[20:23], s47 offen
  s_add_u32 s47, s47, 65536
  buffer_load_dwordx4 v[144:147], v6, s[20:23], s47 offen
  s_add_u32 s47, s47, 65536
  buffer_load_dwordx4 v[148:151], v6, s[20:23], s47 offen
  s_add_u32 s47, s47, 65536
  buffer_load_dwordx4 v[152:155], v6, s[20:23], s47 offen
  s_add_u32 s47, s47, 65536
  buffer_load_dwordx4 v[156:159], v6, s[20:23], s47 offen
  s_add_u32 s47, s47, 65536
  v_mov_b32 v10, 0
  v_mov_b32 v11, 0
  v_mov_b32 v12, 0
  v_mov_b32 v13, 0
  s_mov_b32 s53, 0xffff0000
  v_lshlrev_b32 v14, 2, v4
  v_sub_u32 v14, v3, v14
  v_mov_b32 v15, 0x3f80
  v_mov_b32 v8, 0x3f800000
  v_cmp_eq_u32 vcc, 0, v14
  s_nop 1
  v_cndmask_b32 v112, 0, v15, vcc
  v_cmp_eq_u32 vcc, 1, v14
  s_nop 1
  v_cndmask_b32 v112, v112, v8, vcc
  v_cmp_eq_u32 vcc, 2, v14
  s_nop 1
  v_cndmask_b32 v113, 0, v15, vcc
  v_cmp_eq_u32 vcc, 3, v14
  s_nop 1
  v_cndmask_b32 v113, v113, v8, vcc
  v_cmp_eq_u32 vcc, 8, v14
  s_nop 1
  v_cndmask_b32 v114, 0, v15, vcc
  v_cmp_eq_u32 vcc, 9, v14
  s_nop 1
  v_cndmask_b32 v114, v114, v8, vcc
  v_cmp_eq_u32 vcc, 10, v14
  s_nop 1
  v_cndmask_b32 v115, 0, v15, vcc
  v_cmp_eq_u32 vcc, 11, v14
  s_nop 1
  v_cndmask_b32 v115, v115, v8, vcc
  v_cmp_eq_u32 vcc, 16, v14
  s_nop 1
  v_cndmask_b32 v116, 0, v15, vcc
  v_cmp_eq_u32 vcc, 17, v14
  s_nop 1
  v_cndmask_b32 v116, v116, v8, vcc
  v_cmp_eq_u32 vcc, 18, v14
  s_nop 1
  v_cndmask_b32 v117, 0, v15, vcc
  v_cmp_eq_u32 vcc, 19, v14
  s_nop 1
  v_cndmask_b32 v117, v117, v8, vcc
  v_cmp_eq_u32 vcc, 24, v14
  s_nop 1
  v_cndmask_b32 v118, 0, v15, vcc
  v_cmp_eq_u32 vcc, 25, v14
  s_nop 1
  v_cndmask_b32 v118, v118, v8, vcc
  v_cmp_eq_u32 vcc, 26, v14
  s_nop 1
  v_cndmask_b32 v119, 0, v15, vcc
  v_cmp_eq_u32 vcc, 27, v14
  s_nop 1
  v_cndmask_b32 v119, v119, v8, vcc
  v_add_u32 v9, 49152, v5
  ds_read_b128 v[64:67], v5 offset:0
  ds_read_b128 v[68:71], v5 offset:1024
  ds_read_b128 v[72:75], v5 offset:2048
  ds_read_b128 v[76:79], v5 offset:3072
  ds_read_b128 v[80:83], v5 offset:4096
  ds_read_b128 v[84:87], v5 offset:5120
  ds_read_b128 v[88:91], v5 offset:6144
  ds_read_b128 v[92:95], v5 offset:7168
  ds_read_b128 v[96:99], v5 offset:8192
  s_waitcnt vmcnt(7) lgkmcnt(6)
  v_mfma_f32_32x32x16_bf16 v[16:31], v[64:67], v[128:131], 0
  buffer_load_dwordx4 v[160:163], v6, s[20:23], s47 offen
  s_add_u32 s47, s47, 65536
  v_lshlrev_b32 v100, 16, v128
  v_and_b32 v101, s53, v128
  v_add_f32 v10, v10, v100
  v_add_f32 v11, v11, v101
  v_fmac_f32 v12, v100, v100
  v_fmac_f32 v13, v101, v101
  v_lshlrev_b32 v106, 16, v129
  v_and_b32 v107, s53, v129
  v_mfma_f32_32x32x16_bf16 v[32:47], v[68:71], v[128:131], 0
  v_add_f32 v10, v10, v106
  v_add_f32 v11, v11, v107
  v_fmac_f32 v12, v106, v106
  v_fmac_f32 v13, v107, v107
  v_lshlrev_b32 v100, 16, v130
  v_and_b32 v101, s53, v130
  v_add_f32 v10, v10, v100
  v_add_f32 v11, v11, v101
  v_mfma_f32_32x32x16_bf16 v[48:63], v[72:75], v[128:131], 0
  v_fmac_f32 v12, v100, v100
  v_fmac_f32 v13, v101, v101
  v_lshlrev_b32 v106, 16, v131
  v_and_b32 v107, s53, v131
  v_add_f32 v10, v10, v106
  v_add_f32 v11, v11, v107
  v_fmac_f32 v12, v106, v106
  v_fmac_f32 v13, v107, v107
  ds_read_b128 v[64:67], v5 offset:9216
  ds_read_b128 v[68:71], v5 offset:10240
  ds_read_b128 v[72:75], v5 offset:11264
  s_waitcnt vmcnt(7) lgkmcnt(6)
  v_mfma_f32_32x32x16_bf16 v[16:31], v[76:79], v[132:135], v[16:31]
  buffer_load_dwordx4 v[164:167], v6, s[20:23], s47 offen
  s_add_u32 s47, s47, 65536
  v_lshlrev_b32 v100, 16, v132
  v_and_b32 v101, s53, v132
  v_add_f32 v10, v10, v100
  v_add_f32 v11, v11, v101
  v_fmac_f32 v12, v100, v100
  v_fmac_f32 v13, v101, v101
  v_lshlrev_b32 v106, 16, v133
  v_and_b32 v107, s53, v133
  v_mfma_f32_32x32x16_bf16 v[32:47], v[80:83], v[132:135], v[32:47]
  v_add_f32 v10, v10, v106
  v_add_f32 v11, v11, v107
  v_fmac_f32 v12, v106, v106
  v_fmac_f32 v13, v107, v107
  v_lshlrev_b32 v100, 16, v134
  v_and_b32 v101, s53, v134
  v_add_f32 v10, v10, v100
  v_add_f32 v11, v11, v101
  v_mfma_f32_32x32x16_bf16 v[48:63], v[84:87], v[132:135], v[48:63]
  v_fmac_f32 v12, v100, v100
  v_fmac_f32 v13, v101, v101
  v_lshlrev_b32 v106, 16, v135
  v_and_b32 v107, s53, v135
  v_add_f32 v10, v10, v106
  v_add_f32 v11, v11, v107
  v_fmac_f32 v12, v106, v106
  v_fmac_f32 v13, v107, v107
  ds_read_b128 v[76:79], v5 offset:12288
  ds_read_b128 v[80:83], v5 offset:13312
  ds_read_b128 v[84:87], v5 offset:14336
  s_waitcnt vmcnt(7) lgkmcnt(6)
  v_mfma_f32_32x32x16_bf16 v[16:31], v[88:91], v[136:139], v[16:31]
  buffer_load_dwordx4 v[168:171], v6, s[20:23], s47 offen
  s_add_u32 s47, s47, 65536
  v_lshlrev_b32 v100, 16, v136
  v_and_b32 v101, s53, v136
  v_add_f32 v10, v10, v100
  v_add_f32 v11, v11, v101
  v_fmac_f32 v12, v100, v100
  v_fmac_f32 v13, v101, v101
  v_lshlrev_b32 v106, 16, v137
  v_and_b32 v107, s53, v137
  v_mfma_f32_32x32x16_bf16 v[32:47], v[92:95], v[136:139], v[32:47]
  v_add_f32 v10, v10, v106
  v_add_f32 v11, v11, v107
  v_fmac_f32 v12, v106, v106
  v_fmac_f32 v13, v107, v107
  v_lshlrev_b32 v100, 16, v138
  v_and_b32 v101, s53, v138
  v_add_f32 v10, v10, v100
  v_add_f32 v11, v11, v101
  v_mfma_f32_32x32x16_bf16 v[48:63], v[96:99], v[136:139], v[48:63]
  v_fmac_f32 v12, v100, v100
  v_fmac_f32 v13, v101, v101
  v_lshlrev_b32 v106, 16, v139
  v_and_b32 v107, s53, v139
  v_add_f32 v10, v10, v106
  v_add_f32 v11, v11, v107
  v_fmac_f32 v12, v106, v106
  v_fmac_f32 v13, v107, v107
  ds_read_b128 v[88:91], v5 offset:15360
  ds_read_b128 v[92:95], v5 offset:16384
  ds_read_b128 v[96:99], v5 offset:17408
  s_waitcnt vmcnt(7) lgkmcnt(6)
  v_mfma_f32_32x32x16_bf16 v[16:31], v[64:67], v[140:143], v[16:31]
  buffer_load_dwordx4 v[172:175], v6, s[20:23], s47 offen
  s_add_u32 s47, s47, 65536
  v_lshlrev_b32 v100, 16, v140
  v_and_b32 v101, s53, v140
  v_add_f32 v10, v10, v100
  v_add_f32 v11, v11, v101
  v_fmac_f32 v12, v100, v100
  v_fmac_f32 v13, v101, v101
  v_lshlrev_b32 v106, 16, v141
  v_and_b32 v107, s53, v141
  v_mfma_f32_32x32x16_bf16 v[32:47], v[68:71], v[140:143], v[32:47]
  v_add_f32 v10, v10, v106
  v_add_f32 v11, v11, v107
  v_fmac_f32 v12, v106, v106
  v_fmac_f32 v13, v107, v107
  v_lshlrev_b32 v100, 16, v142
  v_and_b32 v101, s53, v142
  v_add_f32 v10, v10, v100
  v_add_f32 v11, v11, v101
  v_mfma_f32_32x32x16_bf16 v[48:63], v[72:75], v[140:143], v[48:63]
  v_fmac_f32 v12, v100, v100
  v_fmac_f32 v13, v101, v101
  v_lshlrev_b32 v106, 16, v143
  v_and_b32 v107, s53, v143
  v_add_f32 v10, v10, v106
  v_add_f32 v11, v11, v107
  v_fmac_f32 v12, v106, v106
  v_fmac_f32 v13, v107, v107
  ds_read_b128 v[64:67], v5 offset:18432
  ds_read_b128 v[68:71], v5 offset:19456
  ds_read_b128 v[72:75], v5 offset:20480
  s_waitcnt vmcnt(7) lgkmcnt(6)
  v_mfma_f32_32x32x16_bf16 v[16:31], v[76:79], v[144:147], v[16:31]
  buffer_load_dwordx4 v[176:179], v6, s[20:23], s47 offen
  s_add_u32 s47, s47, 65536
  v_lshlrev_b32 v100, 16, v144
  v_and_b32 v101, s53, v144
  v_add_f32 v10, v10, v100
  v_add_f32 v11, v11, v101
  v_fmac_f32 v12, v100, v100
  v_fmac_f32 v13, v101, v101
  v_lshlrev_b32 v106, 16, v145
  v_and_b32 v107, s53, v145
  v_mfma_f32_32x32x16_bf16 v[32:47], v[80:83], v[144:147], v[32:47]
  v_add_f32 v10, v10, v106
  v_add_f32 v11, v11, v107
  v_fmac_f32 v12, v106, v106
  v_fmac_f32 v13, v107, v107
  v_lshlrev_b32 v100, 16, v146
  v_and_b32 v101, s53, v146
  v_add_f32 v10, v10, v100
  v_add_f32 v11, v11, v101
  v_mfma_f32_32x32x16_bf16 v[48:63], v[84:87], v[144:147], v[48:63]
  v_fmac_f32 v12, v100, v100
  v_fmac_f32 v13, v101, v101
  v_lshlrev_b32 v106, 16, v147
  v_and_b32 v107, s53, v147
  v_add_f32 v10, v10, v106
  v_add_f32 v11, v11, v107
  v_fmac_f32 v12, v106, v106
  v_fmac_f32 v13, v107, v107
  ds_read_b128 v[76:79], v5 offset:21504
  ds_read_b128 v[80:83], v5 offset:22528
  ds_read_b128 v[84:87], v5 offset:23552
  s_waitcnt vmcnt(7) lgkmcnt(6)
  v_mfma_f32_32x32x16_bf16 v[16:31], v[88:91], v[148:151], v[16:31]
  buffer_load_dwordx4 v[180:183], v6, s[20:23], s47 offen
  s_add_u32 s47, s47, 65536
  v_lshlrev_b32 v100, 16, v148
  v_and_b32 v101, s53, v148
  v_add_f32 v10, v10, v100
  v_add_f32 v11, v11, v101
  v_fmac_f32 v12, v100, v100
  v_fmac_f32 v13, v101, v101
  v_lshlrev_b32 v106, 16, v149
  v_and_b32 v107, s53, v149
  v_mfma_f32_32x32x16_bf16 v[32:47], v[92:95], v[148:151], v[32:47]
  v_add_f32 v10, v10, v106
  v_add_f32 v11, v11, v107
  v_fmac_f32 v12, v106, v106
  v_fmac_f32 v13, v107, v107
  v_lshlrev_b32 v100, 16, v150
  v_and_b32 v101, s53, v150
  v_add_f32 v10, v10, v100
  v_add_f32 v11, v11, v101
  v_mfma_f32_32x32x16_bf16 v[48:63], v[96:99], v[148:151], v[48:63]
  v_fmac_f32 v12, v100, v100
  v_fmac_f32 v13, v101, v101
  v_lshlrev_b32 v106, 16, v151
  v_and_b32 v107, s53, v151
  v_add_f32 v10, v10, v106
  v_add_f32 v11, v11, v107
  v_fmac_f32 v12, v106, v106
  v_fmac_f32 v13, v107, v107
  ds_read_b128 v[88:91], v5 offset:24576
  ds_read_b128 v[92:95], v5 offset:25600
  ds_read_b128 v[96:99], v5 offset:26624
  s_waitcnt vmcnt(7) lgkmcnt(6)
  v_mfma_f32_32x32x16_bf16 v[16:31], v[64:67], v[152:155], v[16:31]
  buffer_load_dwordx4 v[184:187], v6, s[20:23], s47 offen
  s_add_u32 s47, s47, 65536
  v_lshlrev_b32 v100, 16, v152
  v_and_b32 v101, s53, v152
  v_add_f32 v10, v10, v100
  v_add_f32 v11, v11, v101
  v_fmac_f32 v12, v100, v100
  v_fmac_f32 v13, v101, v101
  v_lshlrev_b32 v106, 16, v153
  v_and_b32 v107, s53, v153
  v_mfma_f32_32x32x16_bf16 v[32:47], v[68:71], v[152:155], v[32:47]
  v_add_f32 v10, v10, v106
  v_add_f32 v11, v11, v107
  v_fmac_f32 v12, v106, v106
  v_fmac_f32 v13, v107, v107
  v_lshlrev_b32 v100, 16, v154
  v_and_b32 v101, s53, v154
  v_add_f32 v10, v10, v100
  v_add_f32 v11, v11, v101
  v_mfma_f32_32x32x16_bf16 v[48:63], v[72:75], v[152:155], v[48:63]
  v_fmac_f32 v12, v100, v100
  v_fmac_f32 v13, v101, v101
  v_lshlrev_b32 v106, 16, v155
  v_and_b32 v107, s53, v155
  v_add_f32 v10, v10, v106
  v_add_f32 v11, v11, v107
  v_fmac_f32 v12, v106, v106
  v_fmac_f32 v13, v107, v107
  ds_read_b128 v[64:67], v5 offset:27648
  ds_read_b128 v[68:71], v5 offset:28672
  ds_read_b128 v[72:75], v5 offset:29696
  s_waitcnt vmcnt(7) lgkmcnt(6)
  v_mfma_f32_32x32x16_bf16 v[16:31], v[76:79], v[156:159], v[16:31]
  buffer_load_dwordx4 v[188:191], v6, s[20:23], s47 offen
  s_add_u32 s47, s47, 65536
  v_lshlrev_b32 v100, 16, v156
  v_and_b32 v101, s53, v156
  v_add_f32 v10, v10, v100
  v_add_f32 v11, v11, v101
  v_fmac_f32 v12, v100, v100
  v_fmac_f32 v13, v101, v101
  v_lshlrev_b32 v106, 16, v157
  v_and_b32 v107, s53, v157
  v_mfma_f32_32x32x16_bf16 v[32:47], v[80:83], v[156:159], v[32:47]
  v_add_f32 v10, v10, v106
  v_add_f32 v11, v11, v107
  v_fmac_f32 v12, v106, v106
  v_fmac_f32 v13, v107, v107
  v_lshlrev_b32 v100, 16, v158
  v_and_b32 v101, s53, v158
  v_add_f32 v10, v10, v100
  v_add_f32 v11, v11, v101
  v_mfma_f32_32x32x16_bf16 v[48:63], v[84:87], v[156:159], v[48:63]
  v_fmac_f32 v12, v100, v100
  v_fmac_f32 v13, v101, v101
  v_lshlrev_b32 v106, 16, v159
  v_and_b32 v107, s53, v159
  v_add_f32 v10, v10, v106
  v_add_f32 v11, v11, v107
  v_fmac_f32 v12, v106, v106
  v_fmac_f32 v13, v107, v107
  ds_read_b128 v[76:79], v5 offset:30720
  ds_read_b128 v[80:83], v5 offset:31744
  ds_read_b128 v[84:87], v5 offset:32768
  s_waitcnt vmcnt(7) lgkmcnt(6)
  v_mfma_f32_32x32x16_bf16 v[16:31], v[88:91], v[160:163], v[16:31]
  buffer_load_dwordx4 v[192:195], v6, s[20:23], s47 offen
  s_add_u32 s47, s47, 65536
  v_lshlrev_b32 v100, 16, v160
  v_and_b32 v101, s53, v160
  v_add_f32 v10, v10, v100
  v_add_f32 v11, v11, v101
  v_fmac_f32 v12, v100, v100
  v_fmac_f32 v13, v101, v101
  v_lshlrev_b32 v106, 16, v161
  v_and_b32 v107, s53, v161
  v_mfma_f32_32x32x16_bf16 v[32:47], v[92:95], v[160:163], v[32:47]
  v_add_f32 v10, v10, v106
  v_add_f32 v11, v11, v107
  v_fmac_f32 v12, v106, v106
  v_fmac_f32 v13, v107, v107
  v_lshlrev_b32 v100, 16, v162
  v_and_b32 v101, s53, v162
  v_add_f32 v10, v10, v100
  v_add_f32 v11, v11, v101
  v_mfma_f32_32x32x16_bf16 v[48:63], v[96:99], v[160:163], v[48:63]
  v_fmac_f32 v12, v100, v100
  v_fmac_f32 v13, v101, v101
  v_lshlrev_b32 v106, 16, v163
  v_and_b32 v107, s53, v163
  v_add_f32 v10, v10, v106
  v_add_f32 v11, v11, v107
  v_fmac_f32 v12, v106, v106
  v_fmac_f32 v13, v107, v107
  ds_read_b128 v[88:91], v5 offset:33792
  ds_read_b128 v[92:95], v5 offset:34816
  ds_read_b128 v[96:99], v5 offset:35840
  s_waitcnt vmcnt(7) lgkmcnt(6)
  v_mfma_f32_32x32x16_bf16 v[16:31], v[64:67], v[164:167], v[16:31]
  buffer_load_dwordx4 v[196:199], v6, s[20:23], s47 offen
  s_add_u32 s47, s47, 65536
  v_lshlrev_b32 v100, 16, v164
  v_and_b32 v101, s53, v164
  v_add_f32 v10, v10, v100
  v_add_f32 v11, v11, v101
  v_fmac_f32 v12, v100, v100
  v_fmac_f32 v13, v101, v101
  v_lshlrev_b32 v106, 16, v165
  v_and_b32 v107, s53, v165
  v_mfma_f32_32x32x16_bf16 v[32:47], v[68:71], v[164:167], v[32:47]
  v_add_f32 v10, v10, v106
  v_add_f32 v11, v11, v107
  v_fmac_f32 v12, v106, v106
  v_fmac_f32 v13, v107, v107
  v_lshlrev_b32 v100, 16, v166
  v_and_b32 v101, s53, v166
  v_add_f32 v10, v10, v100
  v_add_f32 v11, v11, v101
  v_mfma_f32_32x32x16_bf16 v[48:63], v[72:75], v[164:167], v[48:63]
  v_fmac_f32 v12, v100, v100
  v_fmac_f32 v13, v101, v101
  v_lshlrev_b32 v106, 16, v167
  v_and_b32 v107, s53, v167
  v_add_f32 v10, v10, v106
  v_add_f32 v11, v11, v107
  v_fmac_f32 v12, v106, v106
  v_fmac_f32 v13, v107, v107
  ds_read_b128 v[64:67], v5 offset:36864
  ds_read_b128 v[68:71], v5 offset:37888
  ds_read_b128 v[72:75], v5 offset:38912
  s_waitcnt vmcnt(7) lgkmcnt(6)
  v_mfma_f32_32x32x16_bf16 v[16:31], v[76:79], v[168:171], v[16:31]
  buffer_load_dwordx4 v[200:203], v6, s[20:23], s47 offen
  s_add_u32 s47, s47, 65536
  v_lshlrev_b32 v100, 16, v168
  v_and_b32 v101, s53, v168
  v_add_f32 v10, v10, v100
  v_add_f32 v11, v11, v101
  v_fmac_f32 v12, v100, v100
  v_fmac_f32 v13, v101, v101
  v_lshlrev_b32 v106, 16, v169
  v_and_b32 v107, s53, v169
  v_mfma_f32_32x32x16_bf16 v[32:47], v[80:83], v[168:171], v[32:47]
  v_add_f32 v10, v10, v106
  v_add_f32 v11, v11, v107
  v_fmac_f32 v12, v106, v106
  v_fmac_f32 v13, v107, v107
  v_lshlrev_b32 v100, 16, v170
  v_and_b32 v101, s53, v170
  v_add_f32 v10, v10, v100
  v_add_f32 v11, v11, v101
  v_mfma_f32_32x32x16_bf16 v[48:63], v[84:87], v[168:171], v[48:63]
  v_fmac_f32 v12, v100, v100
  v_fmac_f32 v13, v101, v101
  v_lshlrev_b32 v106, 16, v171
  v_and_b32 v107, s53, v171
  v_add_f32 v10, v10, v106
  v_add_f32 v11, v11, v107
  v_fmac_f32 v12, v106, v106
  v_fmac_f32 v13, v107, v107
  ds_read_b128 v[76:79], v5 offset:39936
  ds_read_b128 v[80:83], v5 offset:40960
  ds_read_b128 v[84:87], v5 offset:41984
  s_waitcnt vmcnt(7) lgkmcnt(6)
  v_mfma_f32_32x32x16_bf16 v[16:31], v[88:91], v[172:175], v[16:31]
  buffer_load_dwordx4 v[204:207], v6, s[20:23], s47 offen
  s_add_u32 s47, s47, 65536
  v_lshlrev_b32 v100, 16, v172
  v_and_b32 v101, s53, v172
  v_add_f32 v10, v10, v100
  v_add_f32 v11, v11, v101
  v_fmac_f32 v12, v100, v100
  v_fmac_f32 v13, v101, v101
  v_lshlrev_b32 v106, 16, v173
  v_and_b32 v107, s53, v173
  v_mfma_f32_32x32x16_bf16 v[32:47], v[92:95], v[172:175], v[32:47]
  v_add_f32 v10, v10, v106
  v_add_f32 v11, v11, v107
  v_fmac_f32 v12, v106, v106
  v_fmac_f32 v13, v107, v107
  v_lshlrev_b32 v100, 16, v174
  v_and_b32 v101, s53, v174
  v_add_f32 v10, v10, v100
  v_add_f32 v11, v11, v101
  v_mfma_f32_32x32x16_bf16 v[48:63], v[96:99], v[172:175], v[48:63]
  v_fmac_f32 v12, v100, v100
  v_fmac_f32 v13, v101, v101
  v_lshlrev_b32 v106, 16, v175
  v_and_b32 v107, s53, v175
  v_add_f32 v10, v10, v106
  v_add_f32 v11, v11, v107
  v_fmac_f32 v12, v106, v106
  v_fmac_f32 v13, v107, v107
  ds_read_b128 v[88:91], v5 offset:43008
  ds_read_b128 v[92:95], v5 offset:44032
  ds_read_b128 v[96:99], v5 offset:45056
  s_waitcnt vmcnt(7) lgkmcnt(6)
  v_mfma_f32_32x32x16_bf16 v[16:31], v[64:67], v[176:179], v[16:31]
  buffer_load_dwordx4 v[208:211], v6, s[20:23], s47 offen
  s_add_u32 s47, s47, 65536
  v_lshlrev_b32 v100, 16, v176
  v_and_b32 v101, s53, v176
  v_add_f32 v10, v10, v100
  v_add_f32 v11, v11, v101
  v_fmac_f32 v12, v100, v100
  v_fmac_f32 v13, v101, v101
  v_lshlrev_b32 v106, 16, v177
  v_and_b32 v107, s53, v177
  v_mfma_f32_32x32x16_bf16 v[32:47], v[68:71], v[176:179], v[32:47]
  v_add_f32 v10, v10, v106
  v_add_f32 v11, v11, v107
  v_fmac_f32 v12, v106, v106
  v_fmac_f32 v13, v107, v107
  v_lshlrev_b32 v100, 16, v178
  v_and_b32 v101, s53, v178
  v_add_f32 v10, v10, v100
  v_add_f32 v11, v11, v101
  v_mfma_f32_32x32x16_bf16 v[48:63], v[72:75], v[176:179], v[48:63]
  v_fmac_f32 v12, v100, v100
  v_fmac_f32 v13, v101, v101
  v_lshlrev_b32 v106, 16, v179
  v_and_b32 v107, s53, v179
  v_add_f32 v10, v10, v106
  v_add_f32 v11, v11, v107
  v_fmac_f32 v12, v106, v106
  v_fmac_f32 v13, v107, v107
  ds_read_b128 v[64:67], v5 offset:46080
  ds_read_b128 v[68:71], v5 offset:47104
  ds_read_b128 v[72:75], v5 offset:48128
  s_waitcnt vmcnt(7) lgkmcnt(6)
  v_mfma_f32_32x32x16_bf16 v[16:31], v[76:79], v[180:183], v[16:31]
  buffer_load_dwordx4 v[212:215], v6, s[20:23], s47 offen
  s_add_u32 s47, s47, 65536
  v_lshlrev_b32 v100, 16, v180
  v_and_b32 v101, s53, v180
  v_add_f32 v10, v10, v100
  v_add_f32 v11, v11, v101
  v_fmac_f32 v12, v100, v100
  v_fmac_f32 v13, v101, v101
  v_lshlrev_b32 v106, 16, v181
  v_and_b32 v107, s53, v181
  v_mfma_f32_32x32x16_bf16 v[32:47], v[80:83], v[180:183], v[32:47]
  v_add_f32 v10, v10, v106
  v_add_f32 v11, v11, v107
  v_fmac_f32 v12, v106, v106
  v_fmac_f32 v13, v107, v107
  v_lshlrev_b32 v100, 16, v182
  v_and_b32 v101, s53, v182
  v_add_f32 v10, v10, v100
  v_add_f32 v11, v11, v101
  v_mfma_f32_32x32x16_bf16 v[48:63], v[84:87], v[180:183], v[48:63]
  v_fmac_f32 v12, v100, v100
  v_fmac_f32 v13, v101, v101
  v_lshlrev_b32 v106, 16, v183
  v_and_b32 v107, s53, v183
  v_add_f32 v10, v10, v106
  v_add_f32 v11, v11, v107
  v_fmac_f32 v12, v106, v106
  v_fmac_f32 v13, v107, v107
  ds_read_b128 v[76:79], v9 offset:0
  ds_read_b128 v[80:83], v9 offset:1024
  ds_read_b128 v[84:87], v9 offset:2048
  s_waitcnt vmcnt(7) lgkmcnt(6)
  v_mfma_f32_32x32x16_bf16 v[16:31], v[88:91], v[184:187], v[16:31]
  buffer_load_dwordx4 v[216:219], v6, s[20:23], s47 offen
  s_add_u32 s47, s47, 65536
  v_lshlrev_b32 v100, 16, v184
  v_and_b32 v101, s53, v184
  v_add_f32 v10, v10, v100
  v_add_f32 v11, v11, v101
  v_fmac_f32 v12, v100, v100
  v_fmac_f32 v13, v101, v101
  v_lshlrev_b32 v106, 16, v185
  v_and_b32 v107, s53, v185
  v_mfma_f32_32x32x16_bf16 v[32:47], v[92:95], v[184:187], v[32:47]
  v_add_f32 v10, v10, v106
  v_add_f32 v11, v11, v107
  v_fmac_f32 v12, v106, v106
  v_fmac_f32 v13, v107, v107
  v_lshlrev_b32 v100, 16, v186
  v_and_b32 v101, s53, v186
  v_add_f32 v10, v10, v100
  v_add_f32 v11, v11, v101
  v_mfma_f32_32x32x16_bf16 v[48:63], v[96:99], v[184:187], v[48:63]
  v_fmac_f32 v12, v100, v100
  v_fmac_f32 v13, v101, v101
  v_lshlrev_b32 v106, 16, v187
  v_and_b32 v107, s53, v187
  v_add_f32 v10, v10, v106
  v_add_f32 v11, v11, v107
  v_fmac_f32 v12, v106, v106
  v_fmac_f32 v13, v107, v107
  ds_read_b128 v[88:91], v9 offset:3072
  ds_read_b128 v[92:95], v9 offset:4096
  ds_read_b128 v[96:99], v9 offset:5120
  s_waitcnt vmcnt(7) lgkmcnt(6)
  v_mfma_f32_32x32x16_bf16 v[16:31], v[64:67], v[188:191], v[16:31]
  buffer_load_dwordx4 v[220:223], v6, s[20:23], s47 offen
  s_add_u32 s47, s47, 65536
  v_lshlrev_b32 v100, 16, v188
  v_and_b32 v101, s53, v188
  v_add_f32 v10, v10, v100
  v_add_f32 v11, v11, v101
  v_fmac_f32 v12, v100, v100
  v_fmac_f32 v13, v101, v101
  v_lshlrev_b32 v106, 16, v189
  v_and_b32 v107, s53, v189
  v_mfma_f32_32x32x16_bf16 v[32:47], v[68:71], v[188:191], v[32:47]
  v_add_f32 v10, v10, v106
  v_add_f32 v11, v11, v107
  v_fmac_f32 v12, v106, v106
  v_fmac_f32 v13, v107, v107
  v_lshlrev_b32 v100, 16, v190
  v_and_b32 v101, s53, v190
  v_add_f32 v10, v10, v100
  v_add_f32 v11, v11, v101
  v_mfma_f32_32x32x16_bf16 v[48:63], v[72:75], v[188:191], v[48:63]
  v_fmac_f32 v12, v100, v100
  v_fmac_f32 v13, v101, v101
  v_lshlrev_b32 v106, 16, v191
  v_and_b32 v107, s53, v191
  v_add_f32 v10, v10, v106
  v_add_f32 v11, v11, v107
  v_fmac_f32 v12, v106, v106
  v_fmac_f32 v13, v107, v107
  ds_read_b128 v[64:67], v9 offset:6144
  ds_read_b128 v[68:71], v9 offset:7168
  ds_read_b128 v[72:75], v9 offset:8192
  s_waitcnt vmcnt(7) lgkmcnt(6)
  v_mfma_f32_32x32x16_bf16 v[16:31], v[76:79], v[192:195], v[16:31]
  buffer_load_dwordx4 v[224:227], v6, s[20:23], s47 offen
  s_add_u32 s47, s47, 65536
  v_lshlrev_b32 v100, 16, v192
  v_and_b32 v101, s53, v192
  v_add_f32 v10, v10, v100
  v_add_f32 v11, v11, v101
  v_fmac_f32 v12, v100, v100
  v_fmac_f32 v13, v101, v101
  v_lshlrev_b32 v106, 16, v193
  v_and_b32 v107, s53, v193
  v_mfma_f32_32x32x16_bf16 v[32:47], v[80:83], v[192:195], v[32:47]
  v_add_f32 v10, v10, v106
  v_add_f32 v11, v11, v107
  v_fmac_f32 v12, v106, v106
  v_fmac_f32 v13, v107, v107
  v_lshlrev_b32 v100, 16, v194
  v_and_b32 v101, s53, v194
  v_add_f32 v10, v10, v100
  v_add_f32 v11, v11, v101
  v_mfma_f32_32x32x16_bf16 v[48:63], v[84:87], v[192:195], v[48:63]
  v_fmac_f32 v12, v100, v100
  v_fmac_f32 v13, v101, v101
  v_lshlrev_b32 v106, 16, v195
  v_and_b32 v107, s53, v195
  v_add_f32 v10, v10, v106
  v_add_f32 v11, v11, v107
  v_fmac_f32 v12, v106, v106
  v_fmac_f32 v13, v107, v107
  ds_read_b128 v[76:79], v9 offset:9216
  ds_read_b128 v[80:83], v9 offset:10240
  ds_read_b128 v[84:87], v9 offset:11264
  s_waitcnt vmcnt(7) lgkmcnt(6)
  v_mfma_f32_32x32x16_bf16 v[16:31], v[88:91], v[196:199], v[16:31]
  buffer_load_dwordx4 v[228:231], v6, s[20:23], s47 offen
  s_add_u32 s47, s47, 65536
  v_lshlrev_b32 v100, 16, v196
  v_and_b32 v101, s53, v196
  v_add_f32 v10, v10, v100
  v_add_f32 v11, v11, v101
  v_fmac_f32 v12, v100, v100
  v_fmac_f32 v13, v101, v101
  v_lshlrev_b32 v106, 16, v197
  v_and_b32 v107, s53, v197
  v_mfma_f32_32x32x16_bf16 v[32:47], v[92:95], v[196:199], v[32:47]
  v_add_f32 v10, v10, v106
  v_add_f32 v11, v11, v107
  v_fmac_f32 v12, v106, v106
  v_fmac_f32 v13, v107, v107
  v_lshlrev_b32 v100, 16, v198
  v_and_b32 v101, s53, v198
  v_add_f32 v10, v10, v100
  v_add_f32 v11, v11, v101
  v_mfma_f32_32x32x16_bf16 v[48:63], v[96:99], v[196:199], v[48:63]
  v_fmac_f32 v12, v100, v100
  v_fmac_f32 v13, v101, v101
  v_lshlrev_b32 v106, 16, v199
  v_and_b32 v107, s53, v199
  v_add_f32 v10, v10, v106
  v_add_f32 v11, v11, v107
  v_fmac_f32 v12, v106, v106
  v_fmac_f32 v13, v107, v107
  ds_read_b128 v[88:91], v9 offset:12288
  ds_read_b128 v[92:95], v9 offset:13312
  ds_read_b128 v[96:99], v9 offset:14336
  s_waitcnt vmcnt(7) lgkmcnt(6)
  v_mfma_f32_32x32x16_bf16 v[16:31], v[64:67], v[200:203], v[16:31]
  buffer_load_dwordx4 v[232:235], v6, s[20:23], s47 offen
  s_add_u32 s47, s47, 65536
  v_lshlrev_b32 v100, 16, v200
  v_and_b32 v101, s53, v200
  v_add_f32 v10, v10, v100
  v_add_f32 v11, v11, v101
  v_fmac_f32 v12, v100, v100
  v_fmac_f32 v13, v101, v101
  v_lshlrev_b32 v106, 16, v201
  v_and_b32 v107, s53, v201
  v_mfma_f32_32x32x16_bf16 v[32:47], v[68:71], v[200:203], v[32:47]
  v_add_f32 v10, v10, v106
  v_add_f32 v11, v11, v107
  v_fmac_f32 v12, v106, v106
  v_fmac_f32 v13, v107, v107
  v_lshlrev_b32 v100, 16, v202
  v_and_b32 v101, s53, v202
  v_add_f32 v10, v10, v100
  v_add_f32 v11, v11, v101
  v_mfma_f32_32x32x16_bf16 v[48:63], v[72:75], v[200:203], v[48:63]
  v_fmac_f32 v12, v100, v100
  v_fmac_f32 v13, v101, v101
  v_lshlrev_b32 v106, 16, v203
  v_and_b32 v107, s53, v203
  v_add_f32 v10, v10, v106
  v_add_f32 v11, v11, v107
  v_fmac_f32 v12, v106, v106
  v_fmac_f32 v13, v107, v107
  ds_read_b128 v[64:67], v9 offset:15360
  ds_read_b128 v[68:71], v9 offset:16384
  ds_read_b128 v[72:75], v9 offset:17408
  s_waitcnt vmcnt(7) lgkmcnt(6)
  v_mfma_f32_32x32x16_bf16 v[16:31], v[76:79], v[204:207], v[16:31]
  buffer_load_dwordx4 v[236:239], v6, s[20:23], s47 offen
  s_add_u32 s47, s47, 65536
  v_lshlrev_b32 v100, 16, v204
  v_and_b32 v101, s53, v204
  v_add_f32 v10, v10, v100
  v_add_f32 v11, v11, v101
  v_fmac_f32 v12, v100, v100
  v_fmac_f32 v13, v101, v101
  v_lshlrev_b32 v106, 16, v205
  v_and_b32 v107, s53, v205
  v_mfma_f32_32x32x16_bf16 v[32:47], v[80:83], v[204:207], v[32:47]
  v_add_f32 v10, v10, v106
  v_add_f32 v11, v11, v107
  v_fmac_f32 v12, v106, v106
  v_fmac_f32 v13, v107, v107
  v_lshlrev_b32 v100, 16, v206
  v_and_b32 v101, s53, v206
  v_add_f32 v10, v10, v100
  v_add_f32 v11, v11, v101
  v_mfma_f32_32x32x16_bf16 v[48:63], v[84:87], v[204:207], v[48:63]
  v_fmac_f32 v12, v100, v100
  v_fmac_f32 v13, v101, v101
  v_lshlrev_b32 v106, 16, v207
  v_and_b32 v107, s53, v207
  v_add_f32 v10, v10, v106
  v_add_f32 v11, v11, v107
  v_fmac_f32 v12, v106, v106
  v_fmac_f32 v13, v107, v107
  ds_read_b128 v[76:79], v9 offset:18432
  ds_read_b128 v[80:83], v9 offset:19456
  ds_read_b128 v[84:87], v9 offset:20480
  s_waitcnt vmcnt(7) lgkmcnt(6)
  v_mfma_f32_32x32x16_bf16 v[16:31], v[88:91], v[208:211], v[16:31]
  buffer_load_dwordx4 v[240:243], v6, s[20:23], s47 offen
  s_add_u32 s47, s47, 65536
  v_lshlrev_b32 v100, 16, v208
  v_and_b32 v101, s53, v208
  v_add_f32 v10, v10, v100
  v_add_f32 v11, v11, v101
  v_fmac_f32 v12, v100, v100
  v_fmac_f32 v13, v101, v101
  v_lshlrev_b32 v106, 16, v209
  v_and_b32 v107, s53, v209
  v_mfma_f32_32x32x16_bf16 v[32:47], v[92:95], v[208:211], v[32:47]
  v_add_f32 v10, v10, v106
  v_add_f32 v11, v11, v107
  v_fmac_f32 v12, v106, v106
  v_fmac_f32 v13, v107, v107
  v_lshlrev_b32 v100, 16, v210
  v_and_b32 v101, s53, v210
  v_add_f32 v10, v10, v100
  v_add_f32 v11, v11, v101
  v_mfma_f32_32x32x16_bf16 v[48:63], v[96:99], v[208:211], v[48:63]
  v_fmac_f32 v12, v100, v100
  v_fmac_f32 v13, v101, v101
  v_lshlrev_b32 v106, 16, v211
  v_and_b32 v107, s53, v211
  v_add_f32 v10, v10, v106
  v_add_f32 v11, v11, v107
  v_fmac_f32 v12, v106, v106
  v_fmac_f32 v13, v107, v107
  ds_read_b128 v[88:91], v9 offset:21504
  ds_read_b128 v[92:95], v9 offset:22528
  ds_read_b128 v[96:99], v9 offset:23552
  s_waitcnt vmcnt(7) lgkmcnt(6)
  v_mfma_f32_32x32x16_bf16 v[16:31], v[64:67], v[212:215], v[16:31]
  buffer_load_dwordx4 v[244:247], v6, s[20:23], s47 offen
  s_add_u32 s47, s47, 65536
  v_lshlrev_b32 v100, 16, v212
  v_and_b32 v101, s53, v212
  v_add_f32 v10, v10, v100
  v_add_f32 v11, v11, v101
  v_fmac_f32 v12, v100, v100
  v_fmac_f32 v13, v101, v101
  v_lshlrev_b32 v106, 16, v213
  v_and_b32 v107, s53, v213
  v_mfma_f32_32x32x16_bf16 v[32:47], v[68:71], v[212:215], v[32:47]
  v_add_f32 v10, v10, v106
  v_add_f32 v11, v11, v107
  v_fmac_f32 v12, v106, v106
  v_fmac_f32 v13, v107, v107
  v_lshlrev_b32 v100, 16, v214
  v_and_b32 v101, s53, v214
  v_add_f32 v10, v10, v100
  v_add_f32 v11, v11, v101
  v_mfma_f32_32x32x16_bf16 v[48:63], v[72:75], v[212:215], v[48:63]
  v_fmac_f32 v12, v100, v100
  v_fmac_f32 v13, v101, v101
  v_lshlrev_b32 v106, 16, v215
  v_and_b32 v107, s53, v215
  v_add_f32 v10, v10, v106
  v_add_f32 v11, v11, v107
  v_fmac_f32 v12, v106, v106
  v_fmac_f32 v13, v107, v107
  ds_read_b128 v[64:67], v9 offset:24576
  ds_read_b128 v[68:71], v9 offset:25600
  ds_read_b128 v[72:75], v9 offset:26624
  s_waitcnt vmcnt(7) lgkmcnt(6)
  v_mfma_f32_32x32x16_bf16 v[16:31], v[76:79], v[216:219], v[16:31]
  buffer_load_dwordx4 v[248:251], v6, s[20:23], s47 offen
  s_add_u32 s47, s47, 65536
  v_lshlrev_b32 v100, 16, v216
  v_and_b32 v101, s53, v216
  v_add_f32 v10, v10, v100
  v_add_f32 v11, v11, v101
  v_fmac_f32 v12, v100, v100
  v_fmac_f32 v13, v101, v101
  v_lshlrev_b32 v106, 16, v217
  v_and_b32 v107, s53, v217
  v_mfma_f32_32x32x16_bf16 v[32:47], v[80:83], v[216:219], v[32:47]
  v_add_f32 v10, v10, v106
  v_add_f32 v11, v11, v107
  v_fmac_f32 v12, v106, v106
  v_fmac_f32 v13, v107, v107
  v_lshlrev_b32 v100, 16, v218
  v_and_b32 v101, s53, v218
  v_add_f32 v10, v10, v100
  v_add_f32 v11, v11, v101
  v_mfma_f32_32x32x16_bf16 v[48:63], v[84:87], v[216:219], v[48:63]
  v_fmac_f32 v12, v100, v100
  v_fmac_f32 v13, v101, v101
  v_lshlrev_b32 v106, 16, v219
  v_and_b32 v107, s53, v219
  v_add_f32 v10, v10, v106
  v_add_f32 v11, v11, v107
  v_fmac_f32 v12, v106, v106
  v_fmac_f32 v13, v107, v107
  ds_read_b128 v[76:79], v9 offset:27648
  ds_read_b128 v[80:83], v9 offset:28672
  ds_read_b128 v[84:87], v9 offset:29696
  s_waitcnt vmcnt(7) lgkmcnt(6)
  v_mfma_f32_32x32x16_bf16 v[16:31], v[88:91], v[220:223], v[16:31]
  buffer_load_dwordx4 v[252:255], v6, s[20:23], s47 offen
  s_add_u32 s47, s47, 65536
  v_lshlrev_b32 v100, 16, v220
  v_and_b32 v101, s53, v220
  v_add_f32 v10, v10, v100
  v_add_f32 v11, v11, v101
  v_fmac_f32 v12, v100, v100
  v_fmac_f32 v13, v101, v101
  v_lshlrev_b32 v106, 16, v221
  v_and_b32 v107, s53, v221
  v_mfma_f32_32x32x16_bf16 v[32:47], v[92:95], v[220:223], v[32:47]
  v_add_f32 v10, v10, v106
  v_add_f32 v11, v11, v107
  v_fmac_f32 v12, v106, v106
  v_fmac_f32 v13, v107, v107
  v_lshlrev_b32 v100, 16, v222
  v_and_b32 v101, s53, v222
  v_add_f32 v10, v10, v100
  v_add_f32 v11, v11, v101
  v_mfma_f32_32x32x16_bf16 v[48:63], v[96:99], v[220:223], v[48:63]
  v_fmac_f32 v12, v100, v100
  v_fmac_f32 v13, v101, v101
  v_lshlrev_b32 v106, 16, v223
  v_and_b32 v107, s53, v223
  v_add_f32 v10, v10, v106
  v_add_f32 v11, v11, v107
  v_fmac_f32 v12, v106, v106
  v_fmac_f32 v13, v107, v107
  ds_read_b128 v[88:91], v9 offset:30720
  ds_read_b128 v[92:95], v9 offset:31744
  ds_read_b128 v[96:99], v9 offset:32768
  s_waitcnt vmcnt(7) lgkmcnt(6)
  v_mfma_f32_32x32x16_bf16 v[16:31], v[64:67], v[224:227], v[16:31]
  v_lshlrev_b32 v100, 16, v224
  v_and_b32 v101, s53, v224
  v_add_f32 v10, v10, v100
  v_add_f32 v11, v11, v101
  v_fmac_f32 v12, v100, v100
  v_fmac_f32 v13, v101, v101
  v_lshlrev_b32 v106, 16, v225
  v_and_b32 v107, s53, v225
  v_mfma_f32_32x32x16_bf16 v[32:47], v[68:71], v[224:227], v[32:47]
  v_add_f32 v10, v10, v106
  v_add_f32 v11, v11, v107
  v_fmac_f32 v12, v106, v106
  v_fmac_f32 v13, v107, v107
  v_lshlrev_b32 v100, 16, v226
  v_and_b32 v101, s53, v226
  v_add_f32 v10, v10, v100
  v_add_f32 v11, v11, v101
  v_mfma_f32_32x32x16_bf16 v[48:63], v[72:75], v[224:227], v[48:63]
  v_fmac_f32 v12, v100, v100
  v_fmac_f32 v13, v101, v101
  v_lshlrev_b32 v106, 16, v227
  v_and_b32 v107, s53, v227
  v_add_f32 v10, v10, v106
  v_add_f32 v11, v11, v107
  v_fmac_f32 v12, v106, v106
  v_fmac_f32 v13, v107, v107
  ds_read_b128 v[64:67], v9 offset:33792
  ds_read_b128 v[68:71], v9 offset:34816
  ds_read_b128 v[72:75], v9 offset:35840
  s_waitcnt vmcnt(6) lgkmcnt(6)
  v_mfma_f32_32x32x16_bf16 v[16:31], v[76:79], v[228:231], v[16:31]
  v_lshlrev_b32 v100, 16, v228
  v_and_b32 v101, s53, v228
  v_add_f32 v10, v10, v100
  v_add_f32 v11, v11, v101
  v_fmac_f32 v12, v100, v100
  v_fmac_f32 v13, v101, v101
  v_lshlrev_b32 v106, 16, v229
  v_and_b32 v107, s53, v229
  v_mfma_f32_32x32x16_bf16 v[32:47], v[80:83], v[228:231], v[32:47]
  v_add_f32 v10, v10, v106
  v_add_f32 v11, v11, v107
  v_fmac_f32 v12, v106, v106
  v_fmac_f32 v13, v107, v107
  v_lshlrev_b32 v100, 16, v230
  v_and_b32 v101, s53, v230
  v_add_f32 v10, v10, v100
  v_add_f32 v11, v11, v101
  v_mfma_f32_32x32x16_bf16 v[48:63], v[84:87], v[228:231], v[48:63]
  v_fmac_f32 v12, v100, v100
  v_fmac_f32 v13, v101, v101
  v_lshlrev_b32 v106, 16, v231
  v_and_b32 v107, s53, v231
  v_add_f32 v10, v10, v106
  v_add_f32 v11, v11, v107
  v_fmac_f32 v12, v106, v106
  v_fmac_f32 v13, v107, v107
  ds_read_b128 v[76:79], v9 offset:36864
  ds_read_b128 v[80:83], v9 offset:37888
  ds_read_b128 v[84:87], v9 offset:38912
  s_waitcnt vmcnt(5) lgkmcnt(6)
  v_mfma_f32_32x32x16_bf16 v[16:31], v[88:91], v[232:235], v[16:31]
  v_lshlrev_b32 v100, 16, v232
  v_and_b32 v101, s53, v232
  v_add_f32 v10, v10, v100
  v_add_f32 v11, v11, v101
  v_fmac_f32 v12, v100, v100
  v_fmac_f32 v13, v101, v101
  v_lshlrev_b32 v106, 16, v233
  v_and_b32 v107, s53, v233
  v_mfma_f32_32x32x16_bf16 v[32:47], v[92:95], v[232:235], v[32:47]
  v_add_f32 v10, v10, v106
  v_add_f32 v11, v11, v107
  v_fmac_f32 v12, v106, v106
  v_fmac_f32 v13, v107, v107
  v_lshlrev_b32 v100, 16, v234
  v_and_b32 v101, s53, v234
  v_add_f32 v10, v10, v100
  v_add_f32 v11, v11, v101
  v_mfma_f32_32x32x16_bf16 v[48:63], v[96:99], v[232:235], v[48:63]
  v_fmac_f32 v12, v100, v100
  v_fmac_f32 v13, v101, v101
  v_lshlrev_b32 v106, 16, v235
  v_and_b32 v107, s53, v235
  v_add_f32 v10, v10, v106
  v_add_f32 v11, v11, v107
  v_fmac_f32 v12, v106, v106
  v_fmac_f32 v13, v107, v107
  ds_read_b128 v[88:91], v9 offset:39936
  ds_read_b128 v[92:95], v9 offset:40960
  ds_read_b128 v[96:99], v9 offset:41984
  s_waitcnt vmcnt(4) lgkmcnt(6)
  v_mfma_f32_32x32x16_bf16 v[16:31], v[64:67], v[236:239], v[16:31]
  v_lshlrev_b32 v100, 16, v236
  v_and_b32 v101, s53, v236
  v_add_f32 v10, v10, v100
  v_add_f32 v11, v11, v101
  v_fmac_f32 v12, v100, v100
  v_fmac_f32 v13, v101, v101
  v_lshlrev_b32 v106, 16, v237
  v_and_b32 v107, s53, v237
  v_mfma_f32_32x32x16_bf16 v[32:47], v[68:71], v[236:239], v[32:47]
  v_add_f32 v10, v10, v106
  v_add_f32 v11, v11, v107
  v_fmac_f32 v12, v106, v106
  v_fmac_f32 v13, v107, v107
  v_lshlrev_b32 v100, 16, v238
  v_and_b32 v101, s53, v238
  v_add_f32 v10, v10, v100
  v_add_f32 v11, v11, v101
  v_mfma_f32_32x32x16_bf16 v[48:63], v[72:75], v[236:239], v[48:63]
  v_fmac_f32 v12, v100, v100
  v_fmac_f32 v13, v101, v101
  v_lshlrev_b32 v106, 16, v239
  v_and_b32 v107, s53, v239
  v_add_f32 v10, v10, v106
  v_add_f32 v11, v11, v107
  v_fmac_f32 v12, v106, v106
  v_fmac_f32 v13, v107, v107
  ds_read_b128 v[64:67], v9 offset:43008
  ds_read_b128 v[68:71], v9 offset:44032
  ds_read_b128 v[72:75], v9 offset:45056
  s_waitcnt vmcnt(3) lgkmcnt(6)
  v_mfma_f32_32x32x16_bf16 v[16:31], v[76:79], v[240:243], v[16:31]
  v_lshlrev_b32 v100, 16, v240
  v_and_b32 v101, s53, v240
  v_add_f32 v10, v10, v100
  v_add_f32 v11, v11, v101
  v_fmac_f32 v12, v100, v100
  v_fmac_f32 v13, v101, v101
  v_lshlrev_b32 v106, 16, v241
  v_and_b32 v107, s53, v241
  v_mfma_f32_32x32x16_bf16 v[32:47], v[80:83], v[240:243], v[32:47]
  v_add_f32 v10, v10, v106
  v_add_f32 v11, v11, v107
  v_fmac_f32 v12, v106, v106
  v_fmac_f32 v13, v107, v107
  v_lshlrev_b32 v100, 16, v242
  v_and_b32 v101, s53, v242
  v_add_f32 v10, v10, v100
  v_add_f32 v11, v11, v101
  v_mfma_f32_32x32x16_bf16 v[48:63], v[84:87], v[240:243], v[48:63]
  v_fmac_f32 v12, v100, v100
  v_fmac_f32 v13, v101, v101
  v_lshlrev_b32 v106, 16, v243
  v_and_b32 v107, s53, v243
  v_add_f32 v10, v10, v106
  v_add_f32 v11, v11, v107
  v_fmac_f32 v12, v106, v106
  v_fmac_f32 v13, v107, v107
  ds_read_b128 v[76:79], v9 offset:46080
  ds_read_b128 v[80:83], v9 offset:47104
  ds_read_b128 v[84:87], v9 offset:48128
  s_waitcnt vmcnt(2) lgkmcnt(6)
  v_mfma_f32_32x32x16_bf16 v[16:31], v[88:91], v[244:247], v[16:31]
  v_lshlrev_b32 v100, 16, v244
  v_and_b32 v101, s53, v244
  v_add_f32 v10, v10, v100
  v_add_f32 v11, v11, v101
  v_fmac_f32 v12, v100, v100
  v_fmac_f32 v13, v101, v101
  v_lshlrev_b32 v106, 16, v245
  v_and_b32 v107, s53, v245
  v_mfma_f32_32x32x16_bf16 v[32:47], v[92:95], v[244:247], v[32:47]
  v_add_f32 v10, v10, v106
  v_add_f32 v11, v11, v107
  v_fmac_f32 v12, v106, v106
  v_fmac_f32 v13, v107, v107
  v_lshlrev_b32 v100, 16, v246
  v_and_b32 v101, s53, v246
  v_add_f32 v10, v10, v100
  v_add_f32 v11, v11, v101
  v_mfma_f32_32x32x16_bf16 v[48:63], v[96:99], v[244:247], v[48:63]
  v_fmac_f32 v12, v100, v100
  v_fmac_f32 v13, v101, v101
  v_lshlrev_b32 v106, 16, v247
  v_and_b32 v107, s53, v247
  v_add_f32 v10, v10, v106
  v_add_f32 v11, v11, v107
  v_fmac_f32 v12, v106, v106
  v_fmac_f32 v13, v107, v107
  s_waitcnt vmcnt(1) lgkmcnt(3)
  v_mfma_f32_32x32x16_bf16 v[16:31], v[64:67], v[248:251], v[16:31]
  v_lshlrev_b32 v100, 16, v248
  v_and_b32 v101, s53, v248
  v_add_f32 v10, v10, v100
  v_add_f32 v11, v11, v101
  v_fmac_f32 v12, v100, v100
  v_fmac_f32 v13, v101, v101
  v_lshlrev_b32 v106, 16, v249
  v_and_b32 v107, s53, v249
  v_mfma_f32_32x32x16_bf16 v[32:47], v[68:71], v[248:251], v[32:47]
  v_add_f32 v10, v10, v106
  v_add_f32 v11, v11, v107
  v_fmac_f32 v12, v106, v106
  v_fmac_f32 v13, v107, v107
  v_lshlrev_b32 v100, 16, v250
  v_and_b32 v101, s53, v250
  v_add_f32 v10, v10, v100
  v_add_f32 v11, v11, v101
  v_mfma_f32_32x32x16_bf16 v[48:63], v[72:75], v[248:251], v[48:63]
  v_fmac_f32 v12, v100, v100
  v_fmac_f32 v13, v101, v101
  v_lshlrev_b32 v106, 16, v251
  v_and_b32 v107, s53, v251
  v_add_f32 v10, v10, v106
  v_add_f32 v11, v11, v107
  v_fmac_f32 v12, v106, v106
  v_fmac_f32 v13, v107, v107
  s_waitcnt vmcnt(0) lgkmcnt(0)
  v_mfma_f32_32x32x16_bf16 v[16:31], v[76:79], v[252:255], v[16:31]
  v_lshlrev_b32 v100, 16, v252
  v_and_b32 v101, s53, v252
  v_add_f32 v10, v10, v100
  v_add_f32 v11, v11, v101
  v_fmac_f32 v12, v100, v100
  v_fmac_f32 v13, v101, v101
  v_lshlrev_b32 v106, 16, v253
  v_and_b32 v107, s53, v253
  v_mfma_f32_32x32x16_bf16 v[32:47], v[80:83], v[252:255], v[32:47]
  v_add_f32 v10, v10, v106
  v_add_f32 v11, v11, v107
  v_fmac_f32 v12, v106, v106
  v_fmac_f32 v13, v107, v107
  v_lshlrev_b32 v100, 16, v254
  v_and_b32 v101, s53, v254
  v_add_f32 v10, v10, v100
  v_add_f32 v11, v11, v101
  v_mfma_f32_32x32x16_bf16 v[48:63], v[84:87], v[252:255], v[48:63]
  v_fmac_f32 v12, v100, v100
  v_fmac_f32 v13, v101, v101
  v_lshlrev_b32 v106, 16, v255
  v_and_b32 v107, s53, v255
  v_add_f32 v10, v10, v106
  v_add_f32 v11, v11, v107
  v_fmac_f32 v12, v106, v106
  v_fmac_f32 v13, v107, v107
  s_bfe_u32 s54, s2, 0x20003
  s_lshl_b32 s54, s54, 2
  s_add_u32 s54, s54, s3
  s_lshl_b32 s54, s54, 15
  s_add_u32 s54, s54, 7340032
  v_accvgpr_read_b32 v128, a128
  v_accvgpr_read_b32 v129, a129
  v_accvgpr_read_b32 v130, a130
  v_accvgpr_read_b32 v131, a131
  v_accvgpr_read_b32 v132, a132
  v_accvgpr_read_b32 v133, a133
  v_accvgpr_read_b32 v134, a134
  v_accvgpr_read_b32 v135, a135
  v_accvgpr_read_b32 v136, a136
  v_accvgpr_read_b32 v137, a137
  v_accvgpr_read_b32 v138, a138
  v_accvgpr_read_b32 v139, a139
  v_accvgpr_read_b32 v140, a140
  v_accvgpr_read_b32 v141, a141
  v_accvgpr_read_b32 v142, a142
  v_accvgpr_read_b32 v143, a143
  v_accvgpr_read_b32 v144, a144
  v_accvgpr_read_b32 v145, a145
  v_accvgpr_read_b32 v146, a146
  v_accvgpr_read_b32 v147, a147
  v_accvgpr_read_b32 v148, a148
  v_accvgpr_read_b32 v149, a149
  v_accvgpr_read_b32 v150, a150
  v_accvgpr_read_b32 v151, a151
  v_accvgpr_read_b32 v152, a152
  v_accvgpr_read_b32 v153, a153
  v_accvgpr_read_b32 v154, a154
  v_accvgpr_read_b32 v155, a155
  v_accvgpr_read_b32 v156, a156
  v_accvgpr_read_b32 v157, a157
  v_accvgpr_read_b32 v158, a158
  v_accvgpr_read_b32 v159, a159
  v_accvgpr_read_b32 v160, a160
  v_accvgpr_read_b32 v161, a161
  v_accvgpr_read_b32 v162, a162
  v_accvgpr_read_b32 v163, a163
  v_accvgpr_read_b32 v164, a164
  v_accvgpr_read_b32 v165, a165
  v_accvgpr_read_b32 v166, a166
  v_accvgpr_read_b32 v167, a167
  v_accvgpr_read_b32 v168, a168
  v_accvgpr_read_b32 v169, a169
  v_accvgpr_read_b32 v170, a170
  v_accvgpr_read_b32 v171, a171
  v_accvgpr_read_b32 v172, a172
  v_accvgpr_read_b32 v173, a173
  v_accvgpr_read_b32 v174, a174
  v_accvgpr_read_b32 v175, a175
  s_add_u32 s4, s54, 0
  s_add_u32 s5, s54, 4096
  s_add_u32 s6, s54, 8192
  s_add_u32 s7, s54, 12288
  s_add_u32 s8, s54, 16384
  s_add_u32 s9, s54, 20480
  s_add_u32 s10, s54, 24576
  s_add_u32 s11, s54, 28672
  buffer_load_dwordx4 a[0:3], v5, s[20:23], s4 offen offset:0
  v_add_f32 v10, v10, v11
  v_add_f32 v12, v12, v13
  s_nop 1
  v_permlane32_swap_b32 v10, v12
  v_add_f32 v64, v10, v12
  v_mov_b32 v66, v64
  s_nop 1
  v_permlane32_swap_b32 v64, v66
  v_mul_f32 v64, 0xbb000000, v64
  v_mul_f32 v66, 0x3b000000, v66
  v_fma_f32 v66, -v64, v64, v66
  buffer_load_dwordx4 a[4:7], v5, s[20:23], s4 offen offset:1024
  v_max_f32 v66, 0, v66
  v_add_f32 v66, 0x3727c5ac, v66
  v_rsq_f32 v66, v66
  s_nop 0
  v_mul_f32 v68, 0x3fb8aa3b, v66
  v_pk_fma_f32 v[48:49], v[160:161], v[64:65], v[48:49] op_sel_hi:[1,0,1]
  v_pk_fma_f32 v[50:51], v[162:163], v[64:65], v[50:51] op_sel_hi:[1,0,1]
  v_pk_fma_f32 v[52:53], v[164:165], v[64:65], v[52:53] op_sel_hi:[1,0,1]
  v_pk_fma_f32 v[54:55], v[166:167], v[64:65], v[54:55] op_sel_hi:[1,0,1]
  v_pk_fma_f32 v[56:57], v[168:169], v[64:65], v[56:57] op_sel_hi:[1,0,1]
  buffer_load_dwordx4 a[8:11], v5, s[20:23], s4 offen offset:2048
  v_pk_fma_f32 v[58:59], v[170:171], v[64:65], v[58:59] op_sel_hi:[1,0,1]
  v_pk_fma_f32 v[60:61], v[172:173], v[64:65], v[60:61] op_sel_hi:[1,0,1]
  v_pk_fma_f32 v[62:63], v[174:175], v[64:65], v[62:63] op_sel_hi:[1,0,1]
  v_pk_fma_f32 v[32:33], v[144:145], v[64:65], v[32:33] op_sel_hi:[1,0,1]
  v_pk_fma_f32 v[34:35], v[146:147], v[64:65], v[34:35] op_sel_hi:[1,0,1]
  v_pk_fma_f32 v[36:37], v[148:149], v[64:65], v[36:37] op_sel_hi:[1,0,1]
  v_pk_fma_f32 v[38:39], v[150:151], v[64:65], v[38:39] op_sel_hi:[1,0,1]
  v_pk_fma_f32 v[40:41], v[152:153], v[64:65], v[40:41] op_sel_hi:[1,0,1]
  v_pk_fma_f32 v[42:43], v[154:155], v[64:65], v[42:43] op_sel_hi:[1,0,1]
  buffer_load_dwordx4 a[12:15], v5, s[20:23], s4 offen offset:3072
  v_pk_fma_f32 v[44:45], v[156:157], v[64:65], v[44:45] op_sel_hi:[1,0,1]
  v_pk_fma_f32 v[46:47], v[158:159], v[64:65], v[46:47] op_sel_hi:[1,0,1]
  v_pk_fma_f32 v[16:17], v[128:129], v[64:65], v[16:17] op_sel_hi:[1,0,1]
  v_pk_fma_f32 v[18:19], v[130:131], v[64:65], v[18:19] op_sel_hi:[1,0,1]
  v_pk_fma_f32 v[20:21], v[132:133], v[64:65], v[20:21] op_sel_hi:[1,0,1]
  v_pk_fma_f32 v[22:23], v[134:135], v[64:65], v[22:23] op_sel_hi:[1,0,1]
  v_pk_fma_f32 v[24:25], v[136:137], v[64:65], v[24:25] op_sel_hi:[1,0,1]
  v_pk_fma_f32 v[26:27], v[138:139], v[64:65], v[26:27] op_sel_hi:[1,0,1]
  v_pk_fma_f32 v[28:29], v[140:141], v[64:65], v[28:29] op_sel_hi:[1,0,1]
  buffer_load_dwordx4 a[16:19], v5, s[20:23], s5 offen offset:0
  v_pk_fma_f32 v[30:31], v[142:143], v[64:65], v[30:31] op_sel_hi:[1,0,1]
  v_pk_mul_f32 v[48:49], v[48:49], v[66:67] op_sel_hi:[1,0]
  v_pk_mul_f32 v[50:51], v[50:51], v[66:67] op_sel_hi:[1,0]
  v_pk_mul_f32 v[52:53], v[52:53], v[66:67] op_sel_hi:[1,0]
  v_pk_mul_f32 v[54:55], v[54:55], v[66:67] op_sel_hi:[1,0]
  v_pk_mul_f32 v[56:57], v[56:57], v[66:67] op_sel_hi:[1,0]
  v_pk_mul_f32 v[58:59], v[58:59], v[66:67] op_sel_hi:[1,0]
  v_pk_mul_f32 v[60:61], v[60:61], v[66:67] op_sel_hi:[1,0]
  v_pk_mul_f32 v[62:63], v[62:63], v[66:67] op_sel_hi:[1,0]
  buffer_load_dwordx4 a[20:23], v5, s[20:23], s5 offen offset:1024
  v_cvt_pk_bf16_f32 v128, v48, v49
  v_cvt_pk_bf16_f32 v129, v50, v51
  v_cvt_pk_bf16_f32 v130, v52, v53
  v_cvt_pk_bf16_f32 v131, v54, v55
  v_cvt_pk_bf16_f32 v132, v56, v57
  v_cvt_pk_bf16_f32 v133, v58, v59
  v_cvt_pk_bf16_f32 v134, v60, v61
  v_cvt_pk_bf16_f32 v135, v62, v63
  v_mfma_f32_32x32x16_bf16 v[176:191], v[128:131], v[112:115], 0
  buffer_load_dwordx4 a[24:27], v5, s[20:23], s5 offen offset:2048
  v_mfma_f32_32x32x16_bf16 v[176:191], v[132:135], v[116:119], v[176:191]
  v_max3_f32 v70, v32, v33, v34
  v_max3_f32 v71, -v32, -v33, -v34
  v_max3_f32 v70, v70, v35, v36
  v_max3_f32 v71, v71, -v35, -v36
  v_max3_f32 v70, v70, v37, v38
  v_max3_f32 v71, v71, -v37, -v38
  v_max_f32 v70, v70, v39
  v_max_f32_e64 v71, v71, -v39
  buffer_load_dwordx4 a[28:31], v5, s[20:23], s5 offen offset:3072
  s_nop 0
  v_permlane32_swap_b32 v70, v71
  v_max_f32 v72, v70, v71
  v_mov_b32 v74, v72
  s_nop 1
  v_permlane32_swap_b32 v72, v74
  v_mul_f32_e64 v72, -v72, v68
  v_mul_f32_e64 v74, -v74, v68
  v_pk_fma_f32 v[76:77], v[32:33], v[68:69], v[72:73] op_sel_hi:[1,0,0]
  v_pk_fma_f32 v[84:85], v[32:33], v[68:69], v[74:75] op_sel_hi:[1,0,0] neg_lo:[1,0,0] neg_hi:[1,0,0]
  v_pk_fma_f32 v[78:79], v[34:35], v[68:69], v[72:73] op_sel_hi:[1,0,0]
  buffer_load_dwordx4 a[32:35], v5, s[20:23], s6 offen offset:0
  v_pk_fma_f32 v[86:87], v[34:35], v[68:69], v[74:75] op_sel_hi:[1,0,0] neg_lo:[1,0,0] neg_hi:[1,0,0]
  v_pk_fma_f32 v[80:81], v[36:37], v[68:69], v[72:73] op_sel_hi:[1,0,0]
  v_pk_fma_f32 v[88:89], v[36:37], v[68:69], v[74:75] op_sel_hi:[1,0,0] neg_lo:[1,0,0] neg_hi:[1,0,0]
  v_pk_fma_f32 v[82:83], v[38:39], v[68:69], v[72:73] op_sel_hi:[1,0,0]
  v_pk_fma_f32 v[90:91], v[38:39], v[68:69], v[74:75] op_sel_hi:[1,0,0] neg_lo:[1,0,0] neg_hi:[1,0,0]
  v_exp_f32 v76, v76
  v_exp_f32 v77, v77
  v_exp_f32 v78, v78
  v_exp_f32 v79, v79
  buffer_load_dwordx4 a[36:39], v5, s[20:23], s6 offen offset:1024
  v_exp_f32 v80, v80
  v_exp_f32 v81, v81
  v_exp_f32 v82, v82
  v_exp_f32 v83, v83
  v_exp_f32 v84, v84
  v_exp_f32 v85, v85
  v_exp_f32 v86, v86
  v_exp_f32 v87, v87
  v_exp_f32 v88, v88
  buffer_load_dwordx4 a[40:43], v5, s[20:23], s6 offen offset:2048
  v_exp_f32 v89, v89
  v_exp_f32 v90, v90
  v_exp_f32 v91, v91
  v_pk_add_f32 v[92:93], v[76:77], v[78:79]
  v_pk_add_f32 v[94:95], v[84:85], v[86:87]
  v_pk_add_f32 v[92:93], v[92:93], v[80:81]
  v_pk_add_f32 v[94:95], v[94:95], v[88:89]
  v_pk_add_f32 v[92:93], v[92:93], v[82:83]
  v_pk_add_f32 v[94:95], v[94:95], v[90:91]
  buffer_load_dwordx4 a[44:47], v5, s[20:23], s6 offen offset:3072
  v_add_f32 v70, v92, v93
  v_add_f32 v71, v94, v95
  s_nop 1
  v_permlane32_swap_b32 v70, v71
  v_add_f32 v72, v70, v71
  v_mov_b32 v74, v72
  s_nop 1
  v_permlane32_swap_b32 v72, v74
  v_rcp_f32 v72, v72
  v_rcp_f32 v74, v74
  v_pk_mul_f32 v[76:77], v[76:77], v[72:73] op_sel_hi:[1,0]
  buffer_load_dwordx4 a[48:51], v5, s[20:23], s7 offen offset:0
  v_pk_mul_f32 v[78:79], v[78:79], v[72:73] op_sel_hi:[1,0]
  v_pk_mul_f32 v[80:81], v[80:81], v[72:73] op_sel_hi:[1,0]
  v_pk_mul_f32 v[82:83], v[82:83], v[72:73] op_sel_hi:[1,0]
  v_pk_mul_f32 v[84:85], v[84:85], v[74:75] op_sel_hi:[1,0]
  v_pk_mul_f32 v[86:87], v[86:87], v[74:75] op_sel_hi:[1,0]
  v_pk_mul_f32 v[88:89], v[88:89], v[74:75] op_sel_hi:[1,0]
  v_pk_mul_f32 v[90:91], v[90:91], v[74:75] op_sel_hi:[1,0]
  v_cvt_pk_bf16_f32 v136, v76, v77
  v_cvt_pk_bf16_f32 v137, v78, v79
  buffer_load_dwordx4 a[52:55], v5, s[20:23], s7 offen offset:1024
  v_cvt_pk_bf16_f32 v138, v80, v81
  v_cvt_pk_bf16_f32 v139, v82, v83
  v_cvt_pk_bf16_f32 v140, v84, v85
  v_cvt_pk_bf16_f32 v141, v86, v87
  v_cvt_pk_bf16_f32 v142, v88, v89
  v_cvt_pk_bf16_f32 v143, v90, v91
  v_mfma_f32_32x32x16_bf16 v[200:215], v[136:139], v[112:115], 0
  s_nop 0
  v_mfma_f32_32x32x16_bf16 v[200:215], v[140:143], v[116:119], v[200:215]
  v_cmp_gt_u32 vcc, 16, v3
  buffer_load_dwordx4 a[56:59], v5, s[20:23], s7 offen offset:2048
  v_mov_b32 v96, 0x3f803f80
  v_cvt_pk_bf16_f32 v192, v176, v177
  v_cvt_pk_bf16_f32 v193, v178, v179
  v_cvt_pk_bf16_f32 v194, v180, v181
  v_cvt_pk_bf16_f32 v195, v182, v183
  v_cvt_pk_bf16_f32 v196, v184, v185
  v_cvt_pk_bf16_f32 v197, v186, v187
  v_cvt_pk_bf16_f32 v198, v188, v189
  v_cvt_pk_bf16_f32 v199, v190, v191
  buffer_load_dwordx4 a[60:63], v5, s[20:23], s7 offen offset:3072
  v_cndmask_b32 v152, v96, v192, vcc
  v_cndmask_b32 v160, v192, v96, vcc
  v_cndmask_b32 v153, v96, v193, vcc
  v_cndmask_b32 v161, v193, v96, vcc
  v_cndmask_b32 v154, v96, v194, vcc
  v_cndmask_b32 v162, v194, v96, vcc
  v_cndmask_b32 v155, v96, v195, vcc
  v_cndmask_b32 v163, v195, v96, vcc
  v_cndmask_b32 v156, v96, v196, vcc
  buffer_load_dwordx4 a[64:67], v5, s[20:23], s8 offen offset:0
  v_cndmask_b32 v164, v196, v96, vcc
  v_cndmask_b32 v157, v96, v197, vcc
  v_cndmask_b32 v165, v197, v96, vcc
  v_cndmask_b32 v158, v96, v198, vcc
  v_cndmask_b32 v166, v198, v96, vcc
  v_cndmask_b32 v159, v96, v199, vcc
  v_cndmask_b32 v167, v199, v96, vcc
  v_max3_f32 v70, v40, v41, v42
  v_max3_f32 v71, -v40, -v41, -v42
  buffer_load_dwordx4 a[68:71], v5, s[20:23], s8 offen offset:1024
  v_max3_f32 v70, v70, v43, v44
  v_max3_f32 v71, v71, -v43, -v44
  v_max3_f32 v70, v70, v45, v46
  v_max3_f32 v71, v71, -v45, -v46
  v_max_f32 v70, v70, v47
  v_max_f32_e64 v71, v71, -v47
  s_nop 1
  v_permlane32_swap_b32 v70, v71
  v_max_f32 v72, v70, v71
  v_mov_b32 v74, v72
  buffer_load_dwordx4 a[72:75], v5, s[20:23], s8 offen offset:2048
  s_nop 0
  v_permlane32_swap_b32 v72, v74
  v_mul_f32_e64 v72, -v72, v68
  v_mul_f32_e64 v74, -v74, v68
  v_pk_fma_f32 v[76:77], v[40:41], v[68:69], v[72:73] op_sel_hi:[1,0,0]
  v_pk_fma_f32 v[84:85], v[40:41], v[68:69], v[74:75] op_sel_hi:[1,0,0] neg_lo:[1,0,0] neg_hi:[1,0,0]
  v_pk_fma_f32 v[78:79], v[42:43], v[68:69], v[72:73] op_sel_hi:[1,0,0]
  v_pk_fma_f32 v[86:87], v[42:43], v[68:69], v[74:75] op_sel_hi:[1,0,0] neg_lo:[1,0,0] neg_hi:[1,0,0]
  v_pk_fma_f32 v[80:81], v[44:45], v[68:69], v[72:73] op_sel_hi:[1,0,0]
  v_pk_fma_f32 v[88:89], v[44:45], v[68:69], v[74:75] op_sel_hi:[1,0,0] neg_lo:[1,0,0] neg_hi:[1,0,0]
  buffer_load_dwordx4 a[76:79], v5, s[20:23], s8 offen offset:3072
  v_pk_fma_f32 v[82:83], v[46:47], v[68:69], v[72:73] op_sel_hi:[1,0,0]
  v_pk_fma_f32 v[90:91], v[46:47], v[68:69], v[74:75] op_sel_hi:[1,0,0] neg_lo:[1,0,0] neg_hi:[1,0,0]
  v_exp_f32 v76, v76
  v_exp_f32 v77, v77
  v_exp_f32 v78, v78
  v_exp_f32 v79, v79
  v_exp_f32 v80, v80
  v_exp_f32 v81, v81
  v_exp_f32 v82, v82
  buffer_load_dwordx4 a[80:83], v5, s[20:23], s9 offen offset:0
  v_exp_f32 v83, v83
  v_exp_f32 v84, v84
  v_exp_f32 v85, v85
  v_exp_f32 v86, v86
  v_exp_f32 v87, v87
  v_exp_f32 v88, v88
  v_exp_f32 v89, v89
  v_exp_f32 v90, v90
  v_exp_f32 v91, v91
  buffer_load_dwordx4 a[84:87], v5, s[20:23], s9 offen offset:1024
  v_pk_add_f32 v[92:93], v[76:77], v[78:79]
  v_pk_add_f32 v[94:95], v[84:85], v[86:87]
  v_pk_add_f32 v[92:93], v[92:93], v[80:81]
  v_pk_add_f32 v[94:95], v[94:95], v[88:89]
  v_pk_add_f32 v[92:93], v[92:93], v[82:83]
  v_pk_add_f32 v[94:95], v[94:95], v[90:91]
  v_add_f32 v70, v92, v93
  v_add_f32 v71, v94, v95
  s_nop 1
  v_permlane32_swap_b32 v70, v71
  buffer_load_dwordx4 a[88:91], v5, s[20:23], s9 offen offset:2048
  v_add_f32 v72, v70, v71
  v_mov_b32 v74, v72
  s_nop 1
  v_permlane32_swap_b32 v72, v74
  v_rcp_f32 v72, v72
  v_rcp_f32 v74, v74
  v_pk_mul_f32 v[76:77], v[76:77], v[72:73] op_sel_hi:[1,0]
  v_pk_mul_f32 v[78:79], v[78:79], v[72:73] op_sel_hi:[1,0]
  v_pk_mul_f32 v[80:81], v[80:81], v[72:73] op_sel_hi:[1,0]
  v_pk_mul_f32 v[82:83], v[82:83], v[72:73] op_sel_hi:[1,0]
  buffer_load_dwordx4 a[92:95], v5, s[20:23], s9 offen offset:3072
  v_pk_mul_f32 v[84:85], v[84:85], v[74:75] op_sel_hi:[1,0]
  v_pk_mul_f32 v[86:87], v[86:87], v[74:75] op_sel_hi:[1,0]
  v_pk_mul_f32 v[88:89], v[88:89], v[74:75] op_sel_hi:[1,0]
  v_pk_mul_f32 v[90:91], v[90:91], v[74:75] op_sel_hi:[1,0]
  v_cvt_pk_bf16_f32 v144, v76, v77
  v_cvt_pk_bf16_f32 v145, v78, v79
  v_cvt_pk_bf16_f32 v146, v80, v81
  v_cvt_pk_bf16_f32 v147, v82, v83
  v_cvt_pk_bf16_f32 v148, v84, v85
  buffer_load_dwordx4 a[96:99], v5, s[20:23], s10 offen offset:0
  v_cvt_pk_bf16_f32 v149, v86, v87
  v_cvt_pk_bf16_f32 v150, v88, v89
  v_cvt_pk_bf16_f32 v151, v90, v91
  v_mfma_f32_32x32x16_bf16 v[216:231], v[144:147], v[112:115], 0
  s_nop 0
  v_mfma_f32_32x32x16_bf16 v[216:231], v[148:151], v[116:119], v[216:231]
  s_lshl_b32 s50, s41, 18
  s_lshl_b32 s51, s43, 11
  s_add_u32 s50, s50, s51
  s_add_u32 s50, s50, 16777216
  buffer_load_dwordx4 a[100:103], v5, s[20:23], s10 offen offset:1024
  s_add_u32 s51, s50, 131072
  v_max3_f32 v70, v16, v17, v18
  v_max3_f32 v71, -v16, -v17, -v18
  v_max3_f32 v70, v70, v19, v20
  v_max3_f32 v71, v71, -v19, -v20
  v_max3_f32 v70, v70, v21, v22
  v_max3_f32 v71, v71, -v21, -v22
  v_max_f32 v70, v70, v23
  v_max_f32_e64 v71, v71, -v23
  buffer_load_dwordx4 a[104:107], v5, s[20:23], s10 offen offset:2048
  s_nop 0
  v_permlane32_swap_b32 v70, v71
  v_max_f32 v72, v70, v71
  v_mov_b32 v74, v72
  s_nop 1
  v_permlane32_swap_b32 v72, v74
  v_mul_f32_e64 v72, -v72, v68
  v_mul_f32_e64 v74, -v74, v68
  v_pk_fma_f32 v[76:77], v[16:17], v[68:69], v[72:73] op_sel_hi:[1,0,0]
  v_pk_fma_f32 v[84:85], v[16:17], v[68:69], v[74:75] op_sel_hi:[1,0,0] neg_lo:[1,0,0] neg_hi:[1,0,0]
  v_pk_fma_f32 v[78:79], v[18:19], v[68:69], v[72:73] op_sel_hi:[1,0,0]
  buffer_load_dwordx4 a[108:111], v5, s[20:23], s10 offen offset:3072
  v_pk_fma_f32 v[86:87], v[18:19], v[68:69], v[74:75] op_sel_hi:[1,0,0] neg_lo:[1,0,0] neg_hi:[1,0,0]
  v_pk_fma_f32 v[80:81], v[20:21], v[68:69], v[72:73] op_sel_hi:[1,0,0]
  v_pk_fma_f32 v[88:89], v[20:21], v[68:69], v[74:75] op_sel_hi:[1,0,0] neg_lo:[1,0,0] neg_hi:[1,0,0]
  v_pk_fma_f32 v[82:83], v[22:23], v[68:69], v[72:73] op_sel_hi:[1,0,0]
  v_pk_fma_f32 v[90:91], v[22:23], v[68:69], v[74:75] op_sel_hi:[1,0,0] neg_lo:[1,0,0] neg_hi:[1,0,0]
  v_exp_f32 v76, v76
  v_exp_f32 v77, v77
  v_exp_f32 v78, v78
  v_exp_f32 v79, v79
  buffer_load_dwordx4 a[112:115], v5, s[20:23], s11 offen offset:0
  v_exp_f32 v80, v80
  v_exp_f32 v81, v81
  v_exp_f32 v82, v82
  v_exp_f32 v83, v83
  v_exp_f32 v84, v84
  v_exp_f32 v85, v85
  v_exp_f32 v86, v86
  v_exp_f32 v87, v87
  v_exp_f32 v88, v88
  buffer_load_dwordx4 a[116:119], v5, s[20:23], s11 offen offset:1024
  v_exp_f32 v89, v89
  v_exp_f32 v90, v90
  v_exp_f32 v91, v91
  v_pk_add_f32 v[92:93], v[76:77], v[78:79]
  v_pk_add_f32 v[94:95], v[84:85], v[86:87]
  v_pk_add_f32 v[92:93], v[92:93], v[80:81]
  v_pk_add_f32 v[94:95], v[94:95], v[88:89]
  v_pk_add_f32 v[92:93], v[92:93], v[82:83]
  v_pk_add_f32 v[94:95], v[94:95], v[90:91]
  buffer_load_dwordx4 a[120:123], v5, s[20:23], s11 offen offset:2048
  v_add_f32 v70, v92, v93
  v_add_f32 v71, v94, v95
  s_nop 1
  v_permlane32_swap_b32 v70, v71
  v_add_f32 v72, v70, v71
  v_mov_b32 v74, v72
  s_nop 1
  v_permlane32_swap_b32 v72, v74
  v_rcp_f32 v72, v72
  v_rcp_f32 v74, v74
  v_pk_mul_f32 v[76:77], v[76:77], v[72:73] op_sel_hi:[1,0]
  buffer_load_dwordx4 a[124:127], v5, s[20:23], s11 offen offset:3072
  v_pk_mul_f32 v[78:79], v[78:79], v[72:73] op_sel_hi:[1,0]
  v_pk_mul_f32 v[80:81], v[80:81], v[72:73] op_sel_hi:[1,0]
  v_pk_mul_f32 v[82:83], v[82:83], v[72:73] op_sel_hi:[1,0]
  v_pk_mul_f32 v[84:85], v[84:85], v[74:75] op_sel_hi:[1,0]
  v_pk_mul_f32 v[86:87], v[86:87], v[74:75] op_sel_hi:[1,0]
  v_pk_mul_f32 v[88:89], v[88:89], v[74:75] op_sel_hi:[1,0]
  v_pk_mul_f32 v[90:91], v[90:91], v[74:75] op_sel_hi:[1,0]
  v_cvt_pk_bf16_f32 v100, v76, v77
  v_cvt_pk_bf16_f32 v101, v78, v79
  v_cvt_pk_bf16_f32 v102, v80, v81
  v_cvt_pk_bf16_f32 v103, v82, v83
  v_cvt_pk_bf16_f32 v104, v84, v85
  v_cvt_pk_bf16_f32 v105, v86, v87
  v_cvt_pk_bf16_f32 v106, v88, v89
  v_cvt_pk_bf16_f32 v107, v90, v91
  buffer_store_dwordx4 v[100:103], v5, s[20:23], s50 offen sc0 sc1
  buffer_store_dwordx4 v[104:107], v5, s[20:23], s50 offen offset:1024 sc0 sc1
  v_cvt_pk_bf16_f32 v168, v200, v201
  v_cvt_pk_bf16_f32 v169, v202, v203
  v_cvt_pk_bf16_f32 v170, v204, v205
  v_cvt_pk_bf16_f32 v171, v206, v207
  v_cvt_pk_bf16_f32 v172, v208, v209
  v_cvt_pk_bf16_f32 v173, v210, v211
  v_cvt_pk_bf16_f32 v174, v212, v213
  v_cvt_pk_bf16_f32 v175, v214, v215
  v_mfma_f32_32x32x16_bf16 v[176:191], v[168:171], v[152:155], 0
  s_nop 0
  v_mfma_f32_32x32x16_bf16 v[176:191], v[172:175], v[156:159], v[176:191]
  v_cvt_pk_bf16_f32 v232, v216, v217
  v_cvt_pk_bf16_f32 v233, v218, v219
  v_cvt_pk_bf16_f32 v234, v220, v221
  v_cvt_pk_bf16_f32 v235, v222, v223
  v_cvt_pk_bf16_f32 v236, v224, v225
  v_cvt_pk_bf16_f32 v237, v226, v227
  v_cvt_pk_bf16_f32 v238, v228, v229
  v_cvt_pk_bf16_f32 v239, v230, v231
  v_mfma_f32_32x32x16_bf16 v[32:47], v[232:235], v[160:163], 0
  s_nop 0
  v_mfma_f32_32x32x16_bf16 v[32:47], v[236:239], v[164:167], v[32:47]
  v_mul_u32_u24 v96, 272, v4
  s_mul_i32 s50, s3, 4352
  s_add_u32 s50, s50, 98304
  v_add_u32 v96, s50, v96
  v_min_u32 v97, 16, v3
  v_lshl_add_u32 v97, v97, 4, v96
  v_xor_b32 v98, 16, v3
  v_min_u32 v98, 16, v98
  v_lshl_add_u32 v98, v98, 4, v96
  ds_write_b128 v97, v[176:179] offset:0
  ds_write_b128 v97, v[180:183] offset:544
  ds_write_b128 v97, v[184:187] offset:1088
  ds_write_b128 v97, v[188:191] offset:1632
  ds_write_b128 v98, v[32:35] offset:2176
  ds_write_b128 v98, v[36:39] offset:2720
  ds_write_b128 v98, v[40:43] offset:3264
  ds_write_b128 v98, v[44:47] offset:3808
  v_lshlrev_b32 v96, 2, v0
  v_add_u32 v97, 98304, v96
  s_mul_i32 s50, s41, 4352
  s_add_u32 s50, s50, 20971520
  s_waitcnt lgkmcnt(0)
  s_barrier
  ds_read_b32 v100, v97 offset:0
  ds_read_b32 v101, v97 offset:4352
  ds_read_b32 v102, v97 offset:8704
  ds_read_b32 v103, v97 offset:13056
  ds_read_b32 v104, v97 offset:1024
  ds_read_b32 v105, v97 offset:5376
  ds_read_b32 v106, v97 offset:9728
  ds_read_b32 v107, v97 offset:14080
  ds_read_b32 v108, v97 offset:2048
  ds_read_b32 v109, v97 offset:6400
  ds_read_b32 v110, v97 offset:10752
  ds_read_b32 v111, v97 offset:15104
  s_waitcnt lgkmcnt(0)
  ds_read_b32 v112, v97 offset:3072
  ds_read_b32 v113, v97 offset:7424
  ds_read_b32 v114, v97 offset:11776
  ds_read_b32 v115, v97 offset:16128
  ds_read_b32 v116, v97 offset:4096
  ds_read_b32 v117, v97 offset:8448
  ds_read_b32 v118, v97 offset:12800
  ds_read_b32 v119, v97 offset:17152
  s_waitcnt lgkmcnt(0)
  v_add_f32 v100, v100, v101
  v_add_f32 v102, v102, v103
  v_add_f32 v100, v100, v102
  v_add_f32 v104, v104, v105
  v_add_f32 v106, v106, v107
  v_add_f32 v104, v104, v106
  v_add_f32 v108, v108, v109
  v_add_f32 v110, v110, v111
  v_add_f32 v108, v108, v110
  v_add_f32 v112, v112, v113
  v_add_f32 v114, v114, v115
  v_add_f32 v112, v112, v114
  v_add_f32 v116, v116, v117
  v_add_f32 v118, v118, v119
  v_add_f32 v116, v116, v118
  buffer_atomic_add_f32 v100, v96, s[20:23], s50 offen offset:0 sc1
  buffer_atomic_add_f32 v104, v96, s[20:23], s50 offen offset:1024 sc1
  buffer_atomic_add_f32 v108, v96, s[20:23], s50 offen offset:2048 sc1
  buffer_atomic_add_f32 v112, v96, s[20:23], s50 offen offset:3072 sc1
  s_cmp_lg_u32 s3, 0
  s_cbranch_scc1 K20_na
  s_add_u32 s50, s50, 4096
  buffer_atomic_add_f32 v116, v96, s[20:23], s50 offen sc1
K20_na:
  v_max3_f32 v70, v24, v25, v26
  v_max3_f32 v71, -v24, -v25, -v26
  v_max3_f32 v70, v70, v27, v28
  v_max3_f32 v71, v71, -v27, -v28
  v_max3_f32 v70, v70, v29, v30
  v_max3_f32 v71, v71, -v29, -v30
  v_max_f32 v70, v70, v31
  v_max_f32_e64 v71, v71, -v31
  s_nop 1
  v_permlane32_swap_b32 v70, v71
  v_max_f32 v72, v70, v71
  v_mov_b32 v74, v72
  s_nop 1
  v_permlane32_swap_b32 v72, v74
  v_mul_f32_e64 v72, -v72, v68
  v_mul_f32_e64 v74, -v74, v68
  v_pk_fma_f32 v[76:77], v[24:25], v[68:69], v[72:73] op_sel_hi:[1,0,0]
  v_pk_fma_f32 v[84:85], v[24:25], v[68:69], v[74:75] op_sel_hi:[1,0,0] neg_lo:[1,0,0] neg_hi:[1,0,0]
  v_pk_fma_f32 v[78:79], v[26:27], v[68:69], v[72:73] op_sel_hi:[1,0,0]
  v_pk_fma_f32 v[86:87], v[26:27], v[68:69], v[74:75] op_sel_hi:[1,0,0] neg_lo:[1,0,0] neg_hi:[1,0,0]
  v_pk_fma_f32 v[80:81], v[28:29], v[68:69], v[72:73] op_sel_hi:[1,0,0]
  v_pk_fma_f32 v[88:89], v[28:29], v[68:69], v[74:75] op_sel_hi:[1,0,0] neg_lo:[1,0,0] neg_hi:[1,0,0]
  v_pk_fma_f32 v[82:83], v[30:31], v[68:69], v[72:73] op_sel_hi:[1,0,0]
  v_pk_fma_f32 v[90:91], v[30:31], v[68:69], v[74:75] op_sel_hi:[1,0,0] neg_lo:[1,0,0] neg_hi:[1,0,0]
  v_exp_f32 v76, v76
  v_exp_f32 v77, v77
  v_exp_f32 v78, v78
  v_exp_f32 v79, v79
  v_exp_f32 v80, v80
  v_exp_f32 v81, v81
  v_exp_f32 v82, v82
  v_exp_f32 v83, v83
  v_exp_f32 v84, v84
  v_exp_f32 v85, v85
  v_exp_f32 v86, v86
  v_exp_f32 v87, v87
  v_exp_f32 v88, v88
  v_exp_f32 v89, v89
  v_exp_f32 v90, v90
  v_exp_f32 v91, v91
  v_pk_add_f32 v[92:93], v[76:77], v[78:79]
  v_pk_add_f32 v[94:95], v[84:85], v[86:87]
  v_pk_add_f32 v[92:93], v[92:93], v[80:81]
  v_pk_add_f32 v[94:95], v[94:95], v[88:89]
  v_pk_add_f32 v[92:93], v[92:93], v[82:83]
  v_pk_add_f32 v[94:95], v[94:95], v[90:91]
  v_add_f32 v70, v92, v93
  v_add_f32 v71, v94, v95
  s_nop 1
  v_permlane32_swap_b32 v70, v71
  v_add_f32 v72, v70, v71
  v_mov_b32 v74, v72
  s_nop 1
  v_permlane32_swap_b32 v72, v74
  v_rcp_f32 v72, v72
  v_rcp_f32 v74, v74
  v_pk_mul_f32 v[76:77], v[76:77], v[72:73] op_sel_hi:[1,0]
  v_pk_mul_f32 v[78:79], v[78:79], v[72:73] op_sel_hi:[1,0]
  v_pk_mul_f32 v[80:81], v[80:81], v[72:73] op_sel_hi:[1,0]
  v_pk_mul_f32 v[82:83], v[82:83], v[72:73] op_sel_hi:[1,0]
  v_pk_mul_f32 v[84:85], v[84:85], v[74:75] op_sel_hi:[1,0]
  v_pk_mul_f32 v[86:87], v[86:87], v[74:75] op_sel_hi:[1,0]
  v_pk_mul_f32 v[88:89], v[88:89], v[74:75] op_sel_hi:[1,0]
  v_pk_mul_f32 v[90:91], v[90:91], v[74:75] op_sel_hi:[1,0]
  v_cvt_pk_bf16_f32 v128, v76, v77
  v_cvt_pk_bf16_f32 v129, v78, v79
  v_cvt_pk_bf16_f32 v130, v80, v81
  v_cvt_pk_bf16_f32 v131, v82, v83
  v_cvt_pk_bf16_f32 v132, v84, v85
  v_cvt_pk_bf16_f32 v133, v86, v87
  v_cvt_pk_bf16_f32 v134, v88, v89
  v_cvt_pk_bf16_f32 v135, v90, v91
  buffer_store_dwordx4 v[128:131], v5, s[20:23], s51 offen sc0 sc1
  buffer_store_dwordx4 v[132:135], v5, s[20:23], s51 offen offset:1024 sc0 sc1
K20_end:
  s_waitcnt vmcnt(0) lgkmcnt(0)
  s_barrier
  s_cmp_lg_u32 s3, 0
  s_cbranch_scc1 BAR0_w
  v_mov_b32 v1, 1
  v_lshlrev_b32 v2, 6, v0
  v_lshlrev_b32 v3, 10, v0
  s_lshl_b32 s40, s40, 10
  s_lshl_b32 s41, s41, 6
  s_add_u32 s40, s40, s41
  s_add_u32 s40, s40, 21176320
  s_and_b32 s43, s2, 7
  s_lshl_b32 s43, s43, 1
  s_lshr_b32 s42, s2, 7
  s_add_u32 s43, s43, s42
  s_lshl_b32 s41, s43, 10
  s_add_u32 s41, s41, 21176320
  s_mov_b64 exec, 1
  buffer_store_dword v1, v2, s[20:23], s40 offen sc0 sc1
  s_mov_b64 exec, 0xffff
  s_mov_b32 s42, 0
BAR0_p:
  buffer_load_dword v4, v2, s[20:23], s41 offen sc0 sc1
  s_add_u32 s42, s42, 1
  s_waitcnt vmcnt(0)
  v_cmp_ne_u32 vcc, 1, v4
  s_cbranch_vccz BAR0_pd
  s_cmp_lt_u32 s42, 0x20000
  s_cbranch_scc1 BAR0_p
BAR0_pd:
  s_bfe_u32 s42, s2, 0x40003
  s_cmp_lg_u32 s42, 0
  s_cbranch_scc1 BAR0_n
  s_lshl_b32 s40, s43, 6
  s_add_u32 s40, s40, 21225472
  s_mov_b64 exec, 15
  buffer_store_dword v1, v3, s[20:23], s40 offen sc0 sc1
BAR0_n:
  s_mov_b64 exec, -1
BAR0_w:

  s_barrier
  s_and_b32 s40, s2, 7
  s_lshl_b32 s40, s40, 3
  s_lshr_b32 s41, s2, 5
  s_add_u32 s40, s40, s41
  s_bfe_u32 s41, s2, 0x20003
  v_lshrrev_b32 v1, 6, v0
  v_and_b32 v2, 63, v0
  v_and_b32 v3, 31, v0
  v_readfirstlane_b32 s3, v1
  v_bfe_u32 v4, v0, 5, 1
  v_lshlrev_b32 v5, 4, v2
  v_min_u32 v6, 16, v3
  v_lshlrev_b32 v6, 4, v6
  v_mul_u32_u24 v7, 272, v4
  v_add_u32 v6, v6, v7
  s_mul_i32 s42, s3, 17408
  s_add_u32 s42, s42, 20971520
  s_lshl_b32 s43, s3, 20
  s_lshl_b32 s44, s40, 11
  s_add_u32 s43, s43, s44
  s_add_u32 s43, s43, 16777216
  s_lshl_b32 s44, s41, 2
  s_add_u32 s44, s44, s3
  s_lshl_b32 s45, s44, 15
  s_add_u32 s45, s45, 7340032
  s_waitcnt lgkmcnt(0)
  s_mov_b32 s20, s18
  s_and_b32 s21, s19, 0xffff
  s_mov_b32 s22, 26214400
  s_mov_b32 s23, 0x20000
  buffer_load_dwordx4 v[192:195], v5, s[20:23], s43 offen offset:0
  buffer_load_dwordx4 v[196:199], v5, s[20:23], s43 offen offset:1024
  s_add_u32 s43, s43, 131072
  buffer_load_dwordx4 v[200:203], v5, s[20:23], s43 offen offset:0
  buffer_load_dwordx4 v[204:207], v5, s[20:23], s43 offen offset:1024
  s_add_u32 s43, s43, 131072
  buffer_load_dwordx4 v[208:211], v5, s[20:23], s43 offen offset:0
  buffer_load_dwordx4 v[212:215], v5, s[20:23], s43 offen offset:1024
  s_add_u32 s43, s43, 131072
  buffer_load_dwordx4 v[216:219], v5, s[20:23], s43 offen offset:0
  buffer_load_dwordx4 v[220:223], v5, s[20:23], s43 offen offset:1024
  s_add_u32 s43, s43, 131072
  buffer_load_dwordx4 v[224:227], v5, s[20:23], s43 offen offset:0
  buffer_load_dwordx4 v[228:231], v5, s[20:23], s43 offen offset:1024
  s_add_u32 s43, s43, 131072
  buffer_load_dwordx4 v[232:235], v5, s[20:23], s43 offen offset:0
  buffer_load_dwordx4 v[236:239], v5, s[20:23], s43 offen offset:1024
  s_add_u32 s43, s43, 131072
  buffer_load_dwordx4 v[240:243], v5, s[20:23], s43 offen offset:0
  buffer_load_dwordx4 v[244:247], v5, s[20:23], s43 offen offset:1024
  s_add_u32 s43, s43, 131072
  buffer_load_dwordx4 v[248:251], v5, s[20:23], s43 offen offset:0
  buffer_load_dwordx4 v[252:255], v5, s[20:23], s43 offen offset:1024
  s_lshl_b32 s46, s44, 17
  s_lshl_b32 s47, s40, 9
  s_add_u32 s46, s46, s47
  s_add_u32 s47, s46, 10485760
  s_add_u32 s49, s46, 8388608
  s_add_u32 s46, s46, 14680064
  v_lshlrev_b32 v8, 4, v3
  v_lshl_add_u32 v9, v4, 3, v8
  v_lshl_add_u32 v8, v4, 15, v8
  s_lshl_b32 s48, s3, 13
  v_add_u32 v11, 98304, v5
  v_add_u32 v10, s48, v11
  buffer_load_dwordx2 v[48:49], v9, s[20:23], s47 offen
  s_add_u32 s47, s47, 32768
  buffer_load_dwordx2 v[50:51], v9, s[20:23], s47 offen
  s_add_u32 s47, s47, 32768
  buffer_load_dwordx2 v[52:53], v9, s[20:23], s47 offen
  s_add_u32 s47, s47, 32768
  buffer_load_dwordx2 v[54:55], v9, s[20:23], s47 offen
  s_add_u32 s47, s47, 32768
  buffer_load_dwordx2 a[176:177], v9, s[20:23], s49 offen
  s_add_u32 s49, s49, 32768
  buffer_load_dwordx2 a[178:179], v9, s[20:23], s49 offen
  s_add_u32 s49, s49, 32768
  buffer_load_dwordx2 a[180:181], v9, s[20:23], s49 offen
  s_add_u32 s49, s49, 32768
  buffer_load_dwordx2 a[182:183], v9, s[20:23], s49 offen
  s_add_u32 s49, s49, 32768
  s_cmp_lg_u32 s3, 0
  s_cbranch_scc1 BAR0_x
  v_lshlrev_b32 v14, 6, v0
  s_bfe_u32 s55, s2, 0x20003
  s_lshl_b32 s55, s55, 10
  s_add_u32 s55, s55, 21225472
  s_mov_b64 exec, 0xffff
  s_mov_b32 s51, 0
BAR0_q:
  buffer_load_dword v15, v14, s[20:23], s55 offen sc0 sc1
  s_add_u32 s51, s51, 1
  s_waitcnt vmcnt(0)
  v_cmp_ne_u32 vcc, 1, v15
  s_cbranch_vccz BAR0_qd
  s_cmp_lt_u32 s51, 0x20000
  s_cbranch_scc1 BAR0_q
BAR0_qd:
  s_mov_b64 exec, -1
BAR0_x:
  s_barrier
  buffer_load_dwordx4 v[64:67], v6, s[20:23], s42 offen offset:0
  buffer_load_dwordx4 v[68:71], v6, s[20:23], s42 offen offset:544
  buffer_load_dwordx4 v[72:75], v6, s[20:23], s42 offen offset:1088
  buffer_load_dwordx4 v[76:79], v6, s[20:23], s42 offen offset:1632
  s_add_u32 s42, s42, 2176
  buffer_load_dwordx4 v[80:83], v6, s[20:23], s42 offen offset:0
  buffer_load_dwordx4 v[84:87], v6, s[20:23], s42 offen offset:544
  buffer_load_dwordx4 v[88:91], v6, s[20:23], s42 offen offset:1088
  buffer_load_dwordx4 v[92:95], v6, s[20:23], s42 offen offset:1632
  s_add_u32 s42, s42, 2176
  buffer_load_dwordx4 v[96:99], v6, s[20:23], s42 offen offset:0
  buffer_load_dwordx4 v[100:103], v6, s[20:23], s42 offen offset:544
  buffer_load_dwordx4 v[104:107], v6, s[20:23], s42 offen offset:1088
  buffer_load_dwordx4 v[108:111], v6, s[20:23], s42 offen offset:1632
  s_add_u32 s42, s42, 2176
  buffer_load_dwordx4 v[112:115], v6, s[20:23], s42 offen offset:0
  buffer_load_dwordx4 v[116:119], v6, s[20:23], s42 offen offset:544
  buffer_load_dwordx4 v[120:123], v6, s[20:23], s42 offen offset:1088
  buffer_load_dwordx4 v[124:127], v6, s[20:23], s42 offen offset:1632
  s_add_u32 s42, s42, 2176
  s_waitcnt vmcnt(12)
  v_cvt_pk_bf16_f32 v64, v64, v65
  v_cvt_pk_bf16_f32 v65, v66, v67
  v_cvt_pk_bf16_f32 v66, v68, v69
  v_cvt_pk_bf16_f32 v67, v70, v71
  v_cvt_pk_bf16_f32 v68, v72, v73
  v_cvt_pk_bf16_f32 v69, v74, v75
  v_cvt_pk_bf16_f32 v70, v76, v77
  v_cvt_pk_bf16_f32 v71, v78, v79
  v_mfma_f32_32x32x16_bf16 v[16:31], v[64:67], v[192:195], 0
  s_nop 0
  v_mfma_f32_32x32x16_bf16 v[16:31], v[68:71], v[196:199], v[16:31]
  buffer_load_dwordx4 v[128:131], v6, s[20:23], s42 offen offset:0
  buffer_load_dwordx4 v[132:135], v6, s[20:23], s42 offen offset:544
  buffer_load_dwordx4 v[136:139], v6, s[20:23], s42 offen offset:1088
  buffer_load_dwordx4 v[140:143], v6, s[20:23], s42 offen offset:1632
  s_add_u32 s42, s42, 2176
  s_waitcnt vmcnt(12)
  v_cvt_pk_bf16_f32 v80, v80, v81
  v_cvt_pk_bf16_f32 v81, v82, v83
  v_cvt_pk_bf16_f32 v82, v84, v85
  v_cvt_pk_bf16_f32 v83, v86, v87
  v_cvt_pk_bf16_f32 v84, v88, v89
  v_cvt_pk_bf16_f32 v85, v90, v91
  v_cvt_pk_bf16_f32 v86, v92, v93
  v_cvt_pk_bf16_f32 v87, v94, v95
  v_mfma_f32_32x32x16_bf16 v[32:47], v[80:83], v[200:203], 0
  s_nop 0
  v_mfma_f32_32x32x16_bf16 v[32:47], v[84:87], v[204:207], v[32:47]
  buffer_load_dwordx4 v[144:147], v6, s[20:23], s42 offen offset:0
  buffer_load_dwordx4 v[148:151], v6, s[20:23], s42 offen offset:544
  buffer_load_dwordx4 v[152:155], v6, s[20:23], s42 offen offset:1088
  buffer_load_dwordx4 v[156:159], v6, s[20:23], s42 offen offset:1632
  s_add_u32 s42, s42, 2176
  v_add_f32 v12, 0x358637bd, v24
  v_rcp_f32 v12, v12
  s_nop 0
  v_pk_mul_f32 v[16:17], v[16:17], v[12:13] op_sel_hi:[1,0]
  v_pk_mul_f32 v[18:19], v[18:19], v[12:13] op_sel_hi:[1,0]
  v_pk_mul_f32 v[20:21], v[20:21], v[12:13] op_sel_hi:[1,0]
  v_pk_mul_f32 v[22:23], v[22:23], v[12:13] op_sel_hi:[1,0]
  v_cvt_pk_bf16_f32 v56, v16, v17
  v_cvt_pk_bf16_f32 v57, v18, v19
  v_cvt_pk_bf16_f32 v58, v20, v21
  v_cvt_pk_bf16_f32 v59, v22, v23
  ds_write_b128 v10, v[56:59] offset:0
  s_waitcnt vmcnt(12)
  v_cvt_pk_bf16_f32 v96, v96, v97
  v_cvt_pk_bf16_f32 v97, v98, v99
  v_cvt_pk_bf16_f32 v98, v100, v101
  v_cvt_pk_bf16_f32 v99, v102, v103
  v_cvt_pk_bf16_f32 v100, v104, v105
  v_cvt_pk_bf16_f32 v101, v106, v107
  v_cvt_pk_bf16_f32 v102, v108, v109
  v_cvt_pk_bf16_f32 v103, v110, v111
  v_mfma_f32_32x32x16_bf16 v[16:31], v[96:99], v[208:211], 0
  s_nop 0
  v_mfma_f32_32x32x16_bf16 v[16:31], v[100:103], v[212:215], v[16:31]
  buffer_load_dwordx4 v[160:163], v6, s[20:23], s42 offen offset:0
  buffer_load_dwordx4 v[164:167], v6, s[20:23], s42 offen offset:544
  buffer_load_dwordx4 v[168:171], v6, s[20:23], s42 offen offset:1088
  buffer_load_dwordx4 v[172:175], v6, s[20:23], s42 offen offset:1632
  s_add_u32 s42, s42, 2176
  v_add_f32 v12, 0x358637bd, v40
  v_rcp_f32 v12, v12
  s_nop 0
  v_pk_mul_f32 v[32:33], v[32:33], v[12:13] op_sel_hi:[1,0]
  v_pk_mul_f32 v[34:35], v[34:35], v[12:13] op_sel_hi:[1,0]
  v_pk_mul_f32 v[36:37], v[36:37], v[12:13] op_sel_hi:[1,0]
  v_pk_mul_f32 v[38:39], v[38:39], v[12:13] op_sel_hi:[1,0]
  v_cvt_pk_bf16_f32 v60, v32, v33
  v_cvt_pk_bf16_f32 v61, v34, v35
  v_cvt_pk_bf16_f32 v62, v36, v37
  v_cvt_pk_bf16_f32 v63, v38, v39
  ds_write_b128 v10, v[60:63] offset:1024
  s_waitcnt vmcnt(12)
  v_cvt_pk_bf16_f32 v112, v112, v113
  v_cvt_pk_bf16_f32 v113, v114, v115
  v_cvt_pk_bf16_f32 v114, v116, v117
  v_cvt_pk_bf16_f32 v115, v118, v119
  v_cvt_pk_bf16_f32 v116, v120, v121
  v_cvt_pk_bf16_f32 v117, v122, v123
  v_cvt_pk_bf16_f32 v118, v124, v125
  v_cvt_pk_bf16_f32 v119, v126, v127
  v_mfma_f32_32x32x16_bf16 v[32:47], v[112:115], v[216:219], 0
  s_nop 0
  v_mfma_f32_32x32x16_bf16 v[32:47], v[116:119], v[220:223], v[32:47]
  buffer_load_dwordx4 v[176:179], v6, s[20:23], s42 offen offset:0
  buffer_load_dwordx4 v[180:183], v6, s[20:23], s42 offen offset:544
  buffer_load_dwordx4 v[184:187], v6, s[20:23], s42 offen offset:1088
  buffer_load_dwordx4 v[188:191], v6, s[20:23], s42 offen offset:1632
  v_add_f32 v12, 0x358637bd, v24
  v_rcp_f32 v12, v12
  s_nop 0
  v_pk_mul_f32 v[16:17], v[16:17], v[12:13] op_sel_hi:[1,0]
  v_pk_mul_f32 v[18:19], v[18:19], v[12:13] op_sel_hi:[1,0]
  v_pk_mul_f32 v[20:21], v[20:21], v[12:13] op_sel_hi:[1,0]
  v_pk_mul_f32 v[22:23], v[22:23], v[12:13] op_sel_hi:[1,0]
  v_cvt_pk_bf16_f32 v56, v16, v17
  v_cvt_pk_bf16_f32 v57, v18, v19
  v_cvt_pk_bf16_f32 v58, v20, v21
  v_cvt_pk_bf16_f32 v59, v22, v23
  ds_write_b128 v10, v[56:59] offset:2048
  s_waitcnt vmcnt(12)
  v_cvt_pk_bf16_f32 v128, v128, v129
  v_cvt_pk_bf16_f32 v129, v130, v131
  v_cvt_pk_bf16_f32 v130, v132, v133
  v_cvt_pk_bf16_f32 v131, v134, v135
  v_cvt_pk_bf16_f32 v132, v136, v137
  v_cvt_pk_bf16_f32 v133, v138, v139
  v_cvt_pk_bf16_f32 v134, v140, v141
  v_cvt_pk_bf16_f32 v135, v142, v143
  v_mfma_f32_32x32x16_bf16 v[16:31], v[128:131], v[224:227], 0
  s_nop 0
  v_mfma_f32_32x32x16_bf16 v[16:31], v[132:135], v[228:231], v[16:31]
  v_add_f32 v12, 0x358637bd, v40
  v_rcp_f32 v12, v12
  s_nop 0
  v_pk_mul_f32 v[32:33], v[32:33], v[12:13] op_sel_hi:[1,0]
  v_pk_mul_f32 v[34:35], v[34:35], v[12:13] op_sel_hi:[1,0]
  v_pk_mul_f32 v[36:37], v[36:37], v[12:13] op_sel_hi:[1,0]
  v_pk_mul_f32 v[38:39], v[38:39], v[12:13] op_sel_hi:[1,0]
  v_cvt_pk_bf16_f32 v60, v32, v33
  v_cvt_pk_bf16_f32 v61, v34, v35
  v_cvt_pk_bf16_f32 v62, v36, v37
  v_cvt_pk_bf16_f32 v63, v38, v39
  ds_write_b128 v10, v[60:63] offset:3072
  s_waitcnt vmcnt(8)
  v_cvt_pk_bf16_f32 v144, v144, v145
  v_cvt_pk_bf16_f32 v145, v146, v147
  v_cvt_pk_bf16_f32 v146, v148, v149
  v_cvt_pk_bf16_f32 v147, v150, v151
  v_cvt_pk_bf16_f32 v148, v152, v153
  v_cvt_pk_bf16_f32 v149, v154, v155
  v_cvt_pk_bf16_f32 v150, v156, v157
  v_cvt_pk_bf16_f32 v151, v158, v159
  v_mfma_f32_32x32x16_bf16 v[32:47], v[144:147], v[232:235], 0
  s_nop 0
  v_mfma_f32_32x32x16_bf16 v[32:47], v[148:151], v[236:239], v[32:47]
  v_add_f32 v12, 0x358637bd, v24
  v_rcp_f32 v12, v12
  s_nop 0
  v_pk_mul_f32 v[16:17], v[16:17], v[12:13] op_sel_hi:[1,0]
  v_pk_mul_f32 v[18:19], v[18:19], v[12:13] op_sel_hi:[1,0]
  v_pk_mul_f32 v[20:21], v[20:21], v[12:13] op_sel_hi:[1,0]
  v_pk_mul_f32 v[22:23], v[22:23], v[12:13] op_sel_hi:[1,0]
  v_cvt_pk_bf16_f32 v56, v16, v17
  v_cvt_pk_bf16_f32 v57, v18, v19
  v_cvt_pk_bf16_f32 v58, v20, v21
  v_cvt_pk_bf16_f32 v59, v22, v23
  ds_write_b128 v10, v[56:59] offset:4096
  s_waitcnt vmcnt(4)
  v_cvt_pk_bf16_f32 v160, v160, v161
  v_cvt_pk_bf16_f32 v161, v162, v163
  v_cvt_pk_bf16_f32 v162, v164, v165
  v_cvt_pk_bf16_f32 v163, v166, v167
  v_cvt_pk_bf16_f32 v164, v168, v169
  v_cvt_pk_bf16_f32 v165, v170, v171
  v_cvt_pk_bf16_f32 v166, v172, v173
  v_cvt_pk_bf16_f32 v167, v174, v175
  v_mfma_f32_32x32x16_bf16 v[16:31], v[160:163], v[240:243], 0
  s_nop 0
  v_mfma_f32_32x32x16_bf16 v[16:31], v[164:167], v[244:247], v[16:31]
  v_add_f32 v12, 0x358637bd, v40
  v_rcp_f32 v12, v12
  s_nop 0
  v_pk_mul_f32 v[32:33], v[32:33], v[12:13] op_sel_hi:[1,0]
  v_pk_mul_f32 v[34:35], v[34:35], v[12:13] op_sel_hi:[1,0]
  v_pk_mul_f32 v[36:37], v[36:37], v[12:13] op_sel_hi:[1,0]
  v_pk_mul_f32 v[38:39], v[38:39], v[12:13] op_sel_hi:[1,0]
  v_cvt_pk_bf16_f32 v60, v32, v33
  v_cvt_pk_bf16_f32 v61, v34, v35
  v_cvt_pk_bf16_f32 v62, v36, v37
  v_cvt_pk_bf16_f32 v63, v38, v39
  ds_write_b128 v10, v[60:63] offset:5120
  s_waitcnt vmcnt(0)
  v_cvt_pk_bf16_f32 v176, v176, v177
  v_cvt_pk_bf16_f32 v177, v178, v179
  v_cvt_pk_bf16_f32 v178, v180, v181
  v_cvt_pk_bf16_f32 v179, v182, v183
  v_cvt_pk_bf16_f32 v180, v184, v185
  v_cvt_pk_bf16_f32 v181, v186, v187
  v_cvt_pk_bf16_f32 v182, v188, v189
  v_cvt_pk_bf16_f32 v183, v190, v191
  v_mfma_f32_32x32x16_bf16 v[32:47], v[176:179], v[248:251], 0
  s_nop 0
  v_mfma_f32_32x32x16_bf16 v[32:47], v[180:183], v[252:255], v[32:47]
  v_add_f32 v12, 0x358637bd, v24
  v_rcp_f32 v12, v12
  s_nop 0
  v_pk_mul_f32 v[16:17], v[16:17], v[12:13] op_sel_hi:[1,0]
  v_pk_mul_f32 v[18:19], v[18:19], v[12:13] op_sel_hi:[1,0]
  v_pk_mul_f32 v[20:21], v[20:21], v[12:13] op_sel_hi:[1,0]
  v_pk_mul_f32 v[22:23], v[22:23], v[12:13] op_sel_hi:[1,0]
  v_cvt_pk_bf16_f32 v56, v16, v17
  v_cvt_pk_bf16_f32 v57, v18, v19
  v_cvt_pk_bf16_f32 v58, v20, v21
  v_cvt_pk_bf16_f32 v59, v22, v23
  ds_write_b128 v10, v[56:59] offset:6144
  v_add_f32 v12, 0x358637bd, v40
  v_rcp_f32 v12, v12
  s_nop 0
  v_pk_mul_f32 v[32:33], v[32:33], v[12:13] op_sel_hi:[1,0]
  v_pk_mul_f32 v[34:35], v[34:35], v[12:13] op_sel_hi:[1,0]
  v_pk_mul_f32 v[36:37], v[36:37], v[12:13] op_sel_hi:[1,0]
  v_pk_mul_f32 v[38:39], v[38:39], v[12:13] op_sel_hi:[1,0]
  v_cvt_pk_bf16_f32 v60, v32, v33
  v_cvt_pk_bf16_f32 v61, v34, v35
  v_cvt_pk_bf16_f32 v62, v36, v37
  v_cvt_pk_bf16_f32 v63, v38, v39
  ds_write_b128 v10, v[60:63] offset:7168
  s_waitcnt lgkmcnt(0)
  s_barrier
  ds_read_b128 v[64:67], v11 offset:0
  ds_read_b128 v[68:71], v11 offset:1024
  ds_read_b128 v[72:75], v11 offset:2048
  ds_read_b128 v[76:79], v11 offset:3072
  ds_read_b128 v[80:83], v11 offset:4096
  ds_read_b128 v[84:87], v11 offset:5120
  s_waitcnt lgkmcnt(5)
  v_mfma_f32_32x32x16_bf16 v[16:31], a[0:3], v[64:67], 0
  ds_read_b128 v[64:67], v11 offset:6144
  s_waitcnt lgkmcnt(5)
  v_mfma_f32_32x32x16_bf16 v[16:31], a[4:7], v[68:71], v[16:31]
  ds_read_b128 v[68:71], v11 offset:7168
  s_waitcnt lgkmcnt(5)
  v_mfma_f32_32x32x16_bf16 v[16:31], a[8:11], v[72:75], v[16:31]
  ds_read_b128 v[72:75], v11 offset:8192
  s_waitcnt lgkmcnt(5)
  v_mfma_f32_32x32x16_bf16 v[16:31], a[12:15], v[76:79], v[16:31]
  ds_read_b128 v[76:79], v11 offset:9216
  s_waitcnt lgkmcnt(5)
  v_mfma_f32_32x32x16_bf16 v[16:31], a[16:19], v[80:83], v[16:31]
  ds_read_b128 v[80:83], v11 offset:10240
  s_waitcnt lgkmcnt(5)
  v_mfma_f32_32x32x16_bf16 v[16:31], a[20:23], v[84:87], v[16:31]
  ds_read_b128 v[84:87], v11 offset:11264
  s_waitcnt lgkmcnt(5)
  v_mfma_f32_32x32x16_bf16 v[16:31], a[24:27], v[64:67], v[16:31]
  ds_read_b128 v[64:67], v11 offset:12288
  s_waitcnt lgkmcnt(5)
  v_mfma_f32_32x32x16_bf16 v[16:31], a[28:31], v[68:71], v[16:31]
  ds_read_b128 v[68:71], v11 offset:13312
  s_waitcnt lgkmcnt(5)
  v_mfma_f32_32x32x16_bf16 v[16:31], a[32:35], v[72:75], v[16:31]
  ds_read_b128 v[72:75], v11 offset:14336
  s_waitcnt lgkmcnt(5)
  v_mfma_f32_32x32x16_bf16 v[16:31], a[36:39], v[76:79], v[16:31]
  ds_read_b128 v[76:79], v11 offset:15360
  s_waitcnt lgkmcnt(5)
  v_mfma_f32_32x32x16_bf16 v[16:31], a[40:43], v[80:83], v[16:31]
  ds_read_b128 v[80:83], v11 offset:16384
  s_waitcnt lgkmcnt(5)
  v_mfma_f32_32x32x16_bf16 v[16:31], a[44:47], v[84:87], v[16:31]
  ds_read_b128 v[84:87], v11 offset:17408
  s_waitcnt lgkmcnt(5)
  v_mfma_f32_32x32x16_bf16 v[16:31], a[48:51], v[64:67], v[16:31]
  ds_read_b128 v[64:67], v11 offset:18432
  s_waitcnt lgkmcnt(5)
  v_mfma_f32_32x32x16_bf16 v[16:31], a[52:55], v[68:71], v[16:31]
  ds_read_b128 v[68:71], v11 offset:19456
  s_waitcnt lgkmcnt(5)
  v_mfma_f32_32x32x16_bf16 v[16:31], a[56:59], v[72:75], v[16:31]
  ds_read_b128 v[72:75], v11 offset:20480
  s_waitcnt lgkmcnt(5)
  v_mfma_f32_32x32x16_bf16 v[16:31], a[60:63], v[76:79], v[16:31]
  ds_read_b128 v[76:79], v11 offset:21504
  s_waitcnt lgkmcnt(5)
  v_mfma_f32_32x32x16_bf16 v[16:31], a[64:67], v[80:83], v[16:31]
  ds_read_b128 v[80:83], v11 offset:22528
  s_waitcnt lgkmcnt(5)
  v_mfma_f32_32x32x16_bf16 v[16:31], a[68:71], v[84:87], v[16:31]
  ds_read_b128 v[84:87], v11 offset:23552
  s_waitcnt lgkmcnt(5)
  v_mfma_f32_32x32x16_bf16 v[16:31], a[72:75], v[64:67], v[16:31]
  ds_read_b128 v[64:67], v11 offset:24576
  s_waitcnt lgkmcnt(5)
  v_mfma_f32_32x32x16_bf16 v[16:31], a[76:79], v[68:71], v[16:31]
  ds_read_b128 v[68:71], v11 offset:25600
  s_waitcnt lgkmcnt(5)
  v_mfma_f32_32x32x16_bf16 v[16:31], a[80:83], v[72:75], v[16:31]
  ds_read_b128 v[72:75], v11 offset:26624
  s_waitcnt lgkmcnt(5)
  v_mfma_f32_32x32x16_bf16 v[16:31], a[84:87], v[76:79], v[16:31]
  ds_read_b128 v[76:79], v11 offset:27648
  s_waitcnt lgkmcnt(5)
  v_mfma_f32_32x32x16_bf16 v[16:31], a[88:91], v[80:83], v[16:31]
  ds_read_b128 v[80:83], v11 offset:28672
  s_waitcnt lgkmcnt(5)
  v_mfma_f32_32x32x16_bf16 v[16:31], a[92:95], v[84:87], v[16:31]
  ds_read_b128 v[84:87], v11 offset:29696
  s_waitcnt lgkmcnt(5)
  v_mfma_f32_32x32x16_bf16 v[16:31], a[96:99], v[64:67], v[16:31]
  ds_read_b128 v[64:67], v11 offset:30720
  s_waitcnt lgkmcnt(5)
  v_mfma_f32_32x32x16_bf16 v[16:31], a[100:103], v[68:71], v[16:31]
  ds_read_b128 v[68:71], v11 offset:31744
  s_waitcnt lgkmcnt(5)
  v_mfma_f32_32x32x16_bf16 v[16:31], a[104:107], v[72:75], v[16:31]
  s_waitcnt lgkmcnt(4)
  v_mfma_f32_32x32x16_bf16 v[16:31], a[108:111], v[76:79], v[16:31]
  s_waitcnt lgkmcnt(3)
  v_mfma_f32_32x32x16_bf16 v[16:31], a[112:115], v[80:83], v[16:31]
  s_waitcnt lgkmcnt(2)
  v_mfma_f32_32x32x16_bf16 v[16:31], a[116:119], v[84:87], v[16:31]
  s_waitcnt lgkmcnt(1)
  v_mfma_f32_32x32x16_bf16 v[16:31], a[120:123], v[64:67], v[16:31]
  s_waitcnt lgkmcnt(0)
  v_mfma_f32_32x32x16_bf16 v[16:31], a[124:127], v[68:71], v[16:31]
  s_mov_b32 s53, 0xffff0000
  s_mov_b32 s52, 0x3f803f80
  s_waitcnt vmcnt(0)
  v_lshlrev_b32 v32, 16, v48
  v_and_b32 v33, s53, v48
  v_lshlrev_b32 v34, 16, v49
  v_and_b32 v35, s53, v49
  v_lshlrev_b32 v36, 16, v50
  v_and_b32 v37, s53, v50
  v_lshlrev_b32 v38, 16, v51
  v_and_b32 v39, s53, v51
  v_lshlrev_b32 v40, 16, v52
  v_and_b32 v41, s53, v52
  v_lshlrev_b32 v42, 16, v53
  v_and_b32 v43, s53, v53
  v_lshlrev_b32 v44, 16, v54
  v_and_b32 v45, s53, v54
  v_lshlrev_b32 v46, 16, v55
  v_and_b32 v47, s53, v55
  v_pk_add_f32 v[16:17], v[16:17], v[32:33]
  v_pk_add_f32 v[18:19], v[18:19], v[34:35]
  v_pk_add_f32 v[20:21], v[20:21], v[36:37]
  v_pk_add_f32 v[22:23], v[22:23], v[38:39]
  v_pk_add_f32 v[24:25], v[24:25], v[40:41]
  v_pk_add_f32 v[26:27], v[26:27], v[42:43]
  v_pk_add_f32 v[28:29], v[28:29], v[44:45]
  v_pk_add_f32 v[30:31], v[30:31], v[46:47]
  v_cvt_pk_bf16_f32 v32, v16, v17
  v_cvt_pk_bf16_f32 v33, v18, v19
  v_cvt_pk_bf16_f32 v34, v20, v21
  v_cvt_pk_bf16_f32 v35, v22, v23
  v_cvt_pk_bf16_f32 v36, v24, v25
  v_cvt_pk_bf16_f32 v37, v26, v27
  v_cvt_pk_bf16_f32 v38, v28, v29
  v_cvt_pk_bf16_f32 v39, v30, v31
  v_mov_b32 v12, 0
  v_mov_b32 v13, 0
  v_dot2c_f32_bf16 v12, s52, v32
  v_dot2c_f32_bf16 v13, v32, v32
  v_dot2c_f32_bf16 v12, s52, v33
  v_dot2c_f32_bf16 v13, v33, v33
  v_dot2c_f32_bf16 v12, s52, v34
  v_dot2c_f32_bf16 v13, v34, v34
  v_dot2c_f32_bf16 v12, s52, v35
  v_dot2c_f32_bf16 v13, v35, v35
  v_dot2c_f32_bf16 v12, s52, v36
  v_dot2c_f32_bf16 v13, v36, v36
  v_dot2c_f32_bf16 v12, s52, v37
  v_dot2c_f32_bf16 v13, v37, v37
  v_dot2c_f32_bf16 v12, s52, v38
  v_dot2c_f32_bf16 v13, v38, v38
  v_dot2c_f32_bf16 v12, s52, v39
  v_dot2c_f32_bf16 v13, v39, v39
  v_lshlrev_b32 v6, 5, v3
  s_lshl_b32 s48, s3, 3
  v_add_u32 v11, 98304, v6
  v_add_u32 v7, s48, v11
  s_lshl_b32 s47, s40, 10
  s_add_u32 s47, s47, 21110784
  s_lshl_b32 s48, s41, 3
  s_add_u32 s50, s47, s48
  v_permlane32_swap_b32 v12, v13
  v_add_f32 v14, v12, v13
  v_mov_b32 v15, v14
  s_nop 1
  v_permlane32_swap_b32 v14, v15
  ds_write_b64 v7, v[14:15] offset:32768
  s_waitcnt lgkmcnt(0)
  s_barrier
  ds_read_b128 v[40:43], v11 offset:32768
  ds_read_b128 v[44:47], v11 offset:32784
  v_lshl_add_u32 v7, v4, 4, v6
  s_mov_b32 s48, 0
  s_waitcnt lgkmcnt(0)
  v_pk_add_f32 v[40:41], v[40:41], v[42:43]
  v_pk_add_f32 v[44:45], v[44:45], v[46:47]
  v_pk_add_f32 v[14:15], v[40:41], v[44:45]
  v_or_b32 v14, 1, v14
  v_or_b32 v15, 1, v15
  s_cmp_lg_u32 s3, 0
  s_cbranch_scc1 K3x_skip
  buffer_store_dwordx2 v[14:15], v6, s[20:23], s50 offen sc0 sc1
K3x_skip:
  v_lshlrev_b32 v16, 16, v32
  v_and_b32 v17, s53, v32
  v_lshlrev_b32 v18, 16, v33
  v_and_b32 v19, s53, v33
  v_lshlrev_b32 v20, 16, v34
  v_and_b32 v21, s53, v34
  v_lshlrev_b32 v22, 16, v35
  v_and_b32 v23, s53, v35
  v_lshlrev_b32 v24, 16, v36
  v_and_b32 v25, s53, v36
  v_lshlrev_b32 v26, 16, v37
  v_and_b32 v27, s53, v37
  v_lshlrev_b32 v28, 16, v38
  v_and_b32 v29, s53, v38
  v_lshlrev_b32 v30, 16, v39
  v_and_b32 v31, s53, v39
  v_accvgpr_read_b32 v88, a176
  v_accvgpr_read_b32 v89, a177
  v_accvgpr_read_b32 v90, a178
  v_accvgpr_read_b32 v91, a179
  v_accvgpr_read_b32 v92, a180
  v_accvgpr_read_b32 v93, a181
  v_accvgpr_read_b32 v94, a182
  v_accvgpr_read_b32 v95, a183
  v_lshlrev_b32 v64, 16, v88
  v_and_b32 v65, s53, v88
  v_lshlrev_b32 v66, 16, v89
  v_and_b32 v67, s53, v89
  v_lshlrev_b32 v68, 16, v90
  v_and_b32 v69, s53, v90
  v_lshlrev_b32 v70, 16, v91
  v_and_b32 v71, s53, v91
  v_lshlrev_b32 v72, 16, v92
  v_and_b32 v73, s53, v92
  v_lshlrev_b32 v74, 16, v93
  v_and_b32 v75, s53, v93
  v_lshlrev_b32 v76, 16, v94
  v_and_b32 v77, s53, v94
  v_lshlrev_b32 v78, 16, v95
  v_and_b32 v79, s53, v95
  v_pk_mul_f32 v[96:97], v[16:17], v[64:65]
  v_pk_mul_f32 v[98:99], v[18:19], v[66:67]
  v_pk_mul_f32 v[100:101], v[20:21], v[68:69]
  v_pk_mul_f32 v[102:103], v[22:23], v[70:71]
  v_pk_mul_f32 v[104:105], v[24:25], v[72:73]
  v_pk_mul_f32 v[106:107], v[26:27], v[74:75]
  v_pk_mul_f32 v[108:109], v[28:29], v[76:77]
  v_pk_mul_f32 v[110:111], v[30:31], v[78:79]
K3x_poll:
  buffer_load_dwordx4 v[40:43], v7, s[20:23], s47 offen sc0 sc1
  s_add_u32 s48, s48, 1
  s_waitcnt vmcnt(0)
  v_min_u32 v44, v40, v41
  v_min3_u32 v44, v42, v43, v44
  v_cmp_eq_u32 vcc, 0, v44
  s_cbranch_vccz K3x_done
  s_cmp_lt_u32 s48, 0x20000
  s_cbranch_scc1 K3x_poll
K3x_done:
  v_pk_add_f32 v[12:13], v[40:41], v[42:43]
  s_nop 1
  v_permlane32_swap_b32 v12, v13
  v_add_f32 v14, v12, v13
  v_mov_b32 v15, v14
  s_nop 1
  v_permlane32_swap_b32 v14, v15
  v_mul_f32 v12, 0xbb000000, v14
  v_mul_f32 v15, 0x3b000000, v15
  v_fma_f32 v15, -v12, v12, v15
  v_max_f32 v15, 0, v15
  v_add_f32 v15, 0x3727c5ac, v15
  v_rsq_f32 v14, v15
  v_pk_fma_f32 v[96:97], v[64:65], v[12:13], v[96:97] op_sel_hi:[1,0,1]
  v_pk_fma_f32 v[98:99], v[66:67], v[12:13], v[98:99] op_sel_hi:[1,0,1]
  v_pk_fma_f32 v[100:101], v[68:69], v[12:13], v[100:101] op_sel_hi:[1,0,1]
  v_pk_fma_f32 v[102:103], v[70:71], v[12:13], v[102:103] op_sel_hi:[1,0,1]
  v_pk_fma_f32 v[104:105], v[72:73], v[12:13], v[104:105] op_sel_hi:[1,0,1]
  v_pk_fma_f32 v[106:107], v[74:75], v[12:13], v[106:107] op_sel_hi:[1,0,1]
  v_pk_fma_f32 v[108:109], v[76:77], v[12:13], v[108:109] op_sel_hi:[1,0,1]
  v_pk_fma_f32 v[110:111], v[78:79], v[12:13], v[110:111] op_sel_hi:[1,0,1]
  v_pk_fma_f32 v[16:17], v[96:97], v[14:15], v[16:17] op_sel_hi:[1,0,1]
  v_pk_fma_f32 v[18:19], v[98:99], v[14:15], v[18:19] op_sel_hi:[1,0,1]
  v_pk_fma_f32 v[20:21], v[100:101], v[14:15], v[20:21] op_sel_hi:[1,0,1]
  v_pk_fma_f32 v[22:23], v[102:103], v[14:15], v[22:23] op_sel_hi:[1,0,1]
  v_pk_fma_f32 v[24:25], v[104:105], v[14:15], v[24:25] op_sel_hi:[1,0,1]
  v_pk_fma_f32 v[26:27], v[106:107], v[14:15], v[26:27] op_sel_hi:[1,0,1]
  v_pk_fma_f32 v[28:29], v[108:109], v[14:15], v[28:29] op_sel_hi:[1,0,1]
  v_pk_fma_f32 v[30:31], v[110:111], v[14:15], v[30:31] op_sel_hi:[1,0,1]
  v_cvt_pk_bf16_f32 v32, v16, v17
  v_cvt_pk_bf16_f32 v33, v18, v19
  v_cvt_pk_bf16_f32 v34, v20, v21
  v_cvt_pk_bf16_f32 v35, v22, v23
  v_cvt_pk_bf16_f32 v36, v24, v25
  v_cvt_pk_bf16_f32 v37, v26, v27
  v_cvt_pk_bf16_f32 v38, v28, v29
  v_cvt_pk_bf16_f32 v39, v30, v31
  v_permlane32_swap_b32 v32, v34
  v_permlane32_swap_b32 v33, v35
  v_permlane32_swap_b32 v36, v38
  v_permlane32_swap_b32 v37, v39
  buffer_store_dwordx4 v[32:35], v8, s[20:23], s46 offen sc0 sc1
  s_add_u32 s46, s46, 65536
  buffer_store_dwordx4 v[36:39], v8, s[20:23], s46 offen sc0 sc1
K30_end:
  s_waitcnt vmcnt(0) lgkmcnt(0)
  s_barrier
  s_cmp_lg_u32 s3, 0
  s_cbranch_scc1 BAR1_w
  v_mov_b32 v1, 2
  v_lshlrev_b32 v2, 6, v0
  v_lshlrev_b32 v3, 10, v0
  s_lshl_b32 s40, s40, 8
  s_lshl_b32 s41, s41, 6
  s_add_u32 s40, s40, s41
  s_add_u32 s40, s40, 21192704
  s_and_b32 s43, s2, 3
  s_lshl_b32 s43, s43, 2
  s_bfe_u32 s42, s2, 0x20003
  s_add_u32 s43, s43, s42
  s_lshl_b32 s41, s43, 10
  s_add_u32 s41, s41, 21192704
  s_mov_b64 exec, 1
  buffer_store_dword v1, v2, s[20:23], s40 offen sc0 sc1
  s_mov_b64 exec, 0xffff
  s_mov_b32 s42, 0
BAR1_p:
  buffer_load_dword v4, v2, s[20:23], s41 offen sc0 sc1
  s_add_u32 s42, s42, 1
  s_waitcnt vmcnt(0)
  v_cmp_ne_u32 vcc, 2, v4
  s_cbranch_vccz BAR1_pd
  s_cmp_lt_u32 s42, 0x20000
  s_cbranch_scc1 BAR1_p
BAR1_pd:
  s_mov_b64 exec, -1
BAR1_w:

  s_barrier
  s_and_b32 s40, s2, 3
  s_lshl_b32 s40, s40, 2
  s_bfe_u32 s41, s2, 0x20003
  s_add_u32 s40, s40, s41
  s_bfe_u32 s41, s2, 0x10002
  s_lshl_b32 s41, s41, 3
  s_lshr_b32 s42, s2, 5
  s_add_u32 s41, s41, s42
  v_lshrrev_b32 v1, 6, v0
  v_and_b32 v2, 63, v0
  v_and_b32 v3, 31, v0
  v_readfirstlane_b32 s3, v1
  v_bfe_u32 v4, v0, 5, 1
  v_lshlrev_b32 v5, 4, v2
  v_lshlrev_b32 v6, 4, v3
  v_lshl_add_u32 v6, v4, 15, v6
  s_lshl_b32 s43, s40, 2
  s_add_u32 s43, s43, s3
  s_lshl_b32 s44, s43, 9
  s_mul_i32 s45, s41, 98304
  s_mul_i32 s46, s3, 3072
  s_add_u32 s45, s45, s46
  s_add_u32 s45, s45, 5242880
  s_add_u32 s47, s44, 14680064
  s_add_u32 s48, s44, 8388608
  s_add_u32 s49, s44, 14680064
  s_waitcnt lgkmcnt(0)
  s_mov_b32 s20, s18
  s_and_b32 s21, s19, 0xffff
  s_mov_b32 s22, 26214400
  s_mov_b32 s23, 0x20000
  buffer_load_dwordx4 v[128:131], v6, s[20:23], s47 offen
  s_add_u32 s47, s47, 65536
  buffer_load_dwordx4 v[132:135], v6, s[20:23], s47 offen
  s_add_u32 s47, s47, 65536
  buffer_load_dwordx4 v[136:139], v6, s[20:23], s47 offen
  s_add_u32 s47, s47, 65536
  buffer_load_dwordx4 v[140:143], v6, s[20:23], s47 offen
  s_add_u32 s47, s47, 65536
  buffer_load_dwordx4 v[144:147], v6, s[20:23], s47 offen
  s_add_u32 s47, s47, 65536
  buffer_load_dwordx4 v[148:151], v6, s[20:23], s47 offen
  s_add_u32 s47, s47, 65536
  buffer_load_dwordx4 v[152:155], v6, s[20:23], s47 offen
  s_add_u32 s47, s47, 65536
  buffer_load_dwordx4 v[156:159], v6, s[20:23], s47 offen
  s_add_u32 s47, s47, 65536
  v_mov_b32 v10, 0
  v_mov_b32 v11, 0
  v_mov_b32 v12, 0
  v_mov_b32 v13, 0
  s_mov_b32 s53, 0xffff0000
  v_lshlrev_b32 v14, 2, v4
  v_sub_u32 v14, v3, v14
  v_mov_b32 v15, 0x3f80
  v_mov_b32 v8, 0x3f800000
  v_cmp_eq_u32 vcc, 0, v14
  s_nop 1
  v_cndmask_b32 v112, 0, v15, vcc
  v_cmp_eq_u32 vcc, 1, v14
  s_nop 1
  v_cndmask_b32 v112, v112, v8, vcc
  v_cmp_eq_u32 vcc, 2, v14
  s_nop 1
  v_cndmask_b32 v113, 0, v15, vcc
  v_cmp_eq_u32 vcc, 3, v14
  s_nop 1
  v_cndmask_b32 v113, v113, v8, vcc
  v_cmp_eq_u32 vcc, 8, v14
  s_nop 1
  v_cndmask_b32 v114, 0, v15, vcc
  v_cmp_eq_u32 vcc, 9, v14
  s_nop 1
  v_cndmask_b32 v114, v114, v8, vcc
  v_cmp_eq_u32 vcc, 10, v14
  s_nop 1
  v_cndmask_b32 v115, 0, v15, vcc
  v_cmp_eq_u32 vcc, 11, v14
  s_nop 1
  v_cndmask_b32 v115, v115, v8, vcc
  v_cmp_eq_u32 vcc, 16, v14
  s_nop 1
  v_cndmask_b32 v116, 0, v15, vcc
  v_cmp_eq_u32 vcc, 17, v14
  s_nop 1
  v_cndmask_b32 v116, v116, v8, vcc
  v_cmp_eq_u32 vcc, 18, v14
  s_nop 1
  v_cndmask_b32 v117, 0, v15, vcc
  v_cmp_eq_u32 vcc, 19, v14
  s_nop 1
  v_cndmask_b32 v117, v117, v8, vcc
  v_cmp_eq_u32 vcc, 24, v14
  s_nop 1
  v_cndmask_b32 v118, 0, v15, vcc
  v_cmp_eq_u32 vcc, 25, v14
  s_nop 1
  v_cndmask_b32 v118, v118, v8, vcc
  v_cmp_eq_u32 vcc, 26, v14
  s_nop 1
  v_cndmask_b32 v119, 0, v15, vcc
  v_cmp_eq_u32 vcc, 27, v14
  s_nop 1
  v_cndmask_b32 v119, v119, v8, vcc
  v_add_u32 v9, 49152, v5
  ds_read_b128 v[64:67], v5 offset:0
  ds_read_b128 v[68:71], v5 offset:1024
  ds_read_b128 v[72:75], v5 offset:2048
  ds_read_b128 v[76:79], v5 offset:3072
  ds_read_b128 v[80:83], v5 offset:4096
  ds_read_b128 v[84:87], v5 offset:5120
  ds_read_b128 v[88:91], v5 offset:6144
  ds_read_b128 v[92:95], v5 offset:7168
  ds_read_b128 v[96:99], v5 offset:8192
  s_waitcnt vmcnt(7) lgkmcnt(6)
  v_mfma_f32_32x32x16_bf16 v[16:31], v[64:67], v[128:131], 0
  buffer_load_dwordx4 v[160:163], v6, s[20:23], s47 offen
  s_add_u32 s47, s47, 65536
  v_lshlrev_b32 v100, 16, v128
  v_and_b32 v101, s53, v128
  v_add_f32 v10, v10, v100
  v_add_f32 v11, v11, v101
  v_fmac_f32 v12, v100, v100
  v_fmac_f32 v13, v101, v101
  v_lshlrev_b32 v106, 16, v129
  v_and_b32 v107, s53, v129
  v_mfma_f32_32x32x16_bf16 v[32:47], v[68:71], v[128:131], 0
  v_add_f32 v10, v10, v106
  v_add_f32 v11, v11, v107
  v_fmac_f32 v12, v106, v106
  v_fmac_f32 v13, v107, v107
  v_lshlrev_b32 v100, 16, v130
  v_and_b32 v101, s53, v130
  v_add_f32 v10, v10, v100
  v_add_f32 v11, v11, v101
  v_mfma_f32_32x32x16_bf16 v[48:63], v[72:75], v[128:131], 0
  v_fmac_f32 v12, v100, v100
  v_fmac_f32 v13, v101, v101
  v_lshlrev_b32 v106, 16, v131
  v_and_b32 v107, s53, v131
  v_add_f32 v10, v10, v106
  v_add_f32 v11, v11, v107
  v_fmac_f32 v12, v106, v106
  v_fmac_f32 v13, v107, v107
  ds_read_b128 v[64:67], v5 offset:9216
  ds_read_b128 v[68:71], v5 offset:10240
  ds_read_b128 v[72:75], v5 offset:11264
  s_waitcnt vmcnt(7) lgkmcnt(6)
  v_mfma_f32_32x32x16_bf16 v[16:31], v[76:79], v[132:135], v[16:31]
  buffer_load_dwordx4 v[164:167], v6, s[20:23], s47 offen
  s_add_u32 s47, s47, 65536
  v_lshlrev_b32 v100, 16, v132
  v_and_b32 v101, s53, v132
  v_add_f32 v10, v10, v100
  v_add_f32 v11, v11, v101
  v_fmac_f32 v12, v100, v100
  v_fmac_f32 v13, v101, v101
  v_lshlrev_b32 v106, 16, v133
  v_and_b32 v107, s53, v133
  v_mfma_f32_32x32x16_bf16 v[32:47], v[80:83], v[132:135], v[32:47]
  v_add_f32 v10, v10, v106
  v_add_f32 v11, v11, v107
  v_fmac_f32 v12, v106, v106
  v_fmac_f32 v13, v107, v107
  v_lshlrev_b32 v100, 16, v134
  v_and_b32 v101, s53, v134
  v_add_f32 v10, v10, v100
  v_add_f32 v11, v11, v101
  v_mfma_f32_32x32x16_bf16 v[48:63], v[84:87], v[132:135], v[48:63]
  v_fmac_f32 v12, v100, v100
  v_fmac_f32 v13, v101, v101
  v_lshlrev_b32 v106, 16, v135
  v_and_b32 v107, s53, v135
  v_add_f32 v10, v10, v106
  v_add_f32 v11, v11, v107
  v_fmac_f32 v12, v106, v106
  v_fmac_f32 v13, v107, v107
  ds_read_b128 v[76:79], v5 offset:12288
  ds_read_b128 v[80:83], v5 offset:13312
  ds_read_b128 v[84:87], v5 offset:14336
  s_waitcnt vmcnt(7) lgkmcnt(6)
  v_mfma_f32_32x32x16_bf16 v[16:31], v[88:91], v[136:139], v[16:31]
  buffer_load_dwordx4 v[168:171], v6, s[20:23], s47 offen
  s_add_u32 s47, s47, 65536
  v_lshlrev_b32 v100, 16, v136
  v_and_b32 v101, s53, v136
  v_add_f32 v10, v10, v100
  v_add_f32 v11, v11, v101
  v_fmac_f32 v12, v100, v100
  v_fmac_f32 v13, v101, v101
  v_lshlrev_b32 v106, 16, v137
  v_and_b32 v107, s53, v137
  v_mfma_f32_32x32x16_bf16 v[32:47], v[92:95], v[136:139], v[32:47]
  v_add_f32 v10, v10, v106
  v_add_f32 v11, v11, v107
  v_fmac_f32 v12, v106, v106
  v_fmac_f32 v13, v107, v107
  v_lshlrev_b32 v100, 16, v138
  v_and_b32 v101, s53, v138
  v_add_f32 v10, v10, v100
  v_add_f32 v11, v11, v101
  v_mfma_f32_32x32x16_bf16 v[48:63], v[96:99], v[136:139], v[48:63]
  v_fmac_f32 v12, v100, v100
  v_fmac_f32 v13, v101, v101
  v_lshlrev_b32 v106, 16, v139
  v_and_b32 v107, s53, v139
  v_add_f32 v10, v10, v106
  v_add_f32 v11, v11, v107
  v_fmac_f32 v12, v106, v106
  v_fmac_f32 v13, v107, v107
  ds_read_b128 v[88:91], v5 offset:15360
  ds_read_b128 v[92:95], v5 offset:16384
  ds_read_b128 v[96:99], v5 offset:17408
  s_waitcnt vmcnt(7) lgkmcnt(6)
  v_mfma_f32_32x32x16_bf16 v[16:31], v[64:67], v[140:143], v[16:31]
  buffer_load_dwordx4 v[172:175], v6, s[20:23], s47 offen
  s_add_u32 s47, s47, 65536
  v_lshlrev_b32 v100, 16, v140
  v_and_b32 v101, s53, v140
  v_add_f32 v10, v10, v100
  v_add_f32 v11, v11, v101
  v_fmac_f32 v12, v100, v100
  v_fmac_f32 v13, v101, v101
  v_lshlrev_b32 v106, 16, v141
  v_and_b32 v107, s53, v141
  v_mfma_f32_32x32x16_bf16 v[32:47], v[68:71], v[140:143], v[32:47]
  v_add_f32 v10, v10, v106
  v_add_f32 v11, v11, v107
  v_fmac_f32 v12, v106, v106
  v_fmac_f32 v13, v107, v107
  v_lshlrev_b32 v100, 16, v142
  v_and_b32 v101, s53, v142
  v_add_f32 v10, v10, v100
  v_add_f32 v11, v11, v101
  v_mfma_f32_32x32x16_bf16 v[48:63], v[72:75], v[140:143], v[48:63]
  v_fmac_f32 v12, v100, v100
  v_fmac_f32 v13, v101, v101
  v_lshlrev_b32 v106, 16, v143
  v_and_b32 v107, s53, v143
  v_add_f32 v10, v10, v106
  v_add_f32 v11, v11, v107
  v_fmac_f32 v12, v106, v106
  v_fmac_f32 v13, v107, v107
  ds_read_b128 v[64:67], v5 offset:18432
  ds_read_b128 v[68:71], v5 offset:19456
  ds_read_b128 v[72:75], v5 offset:20480
  s_waitcnt vmcnt(7) lgkmcnt(6)
  v_mfma_f32_32x32x16_bf16 v[16:31], v[76:79], v[144:147], v[16:31]
  buffer_load_dwordx4 v[176:179], v6, s[20:23], s47 offen
  s_add_u32 s47, s47, 65536
  v_lshlrev_b32 v100, 16, v144
  v_and_b32 v101, s53, v144
  v_add_f32 v10, v10, v100
  v_add_f32 v11, v11, v101
  v_fmac_f32 v12, v100, v100
  v_fmac_f32 v13, v101, v101
  v_lshlrev_b32 v106, 16, v145
  v_and_b32 v107, s53, v145
  v_mfma_f32_32x32x16_bf16 v[32:47], v[80:83], v[144:147], v[32:47]
  v_add_f32 v10, v10, v106
  v_add_f32 v11, v11, v107
  v_fmac_f32 v12, v106, v106
  v_fmac_f32 v13, v107, v107
  v_lshlrev_b32 v100, 16, v146
  v_and_b32 v101, s53, v146
  v_add_f32 v10, v10, v100
  v_add_f32 v11, v11, v101
  v_mfma_f32_32x32x16_bf16 v[48:63], v[84:87], v[144:147], v[48:63]
  v_fmac_f32 v12, v100, v100
  v_fmac_f32 v13, v101, v101
  v_lshlrev_b32 v106, 16, v147
  v_and_b32 v107, s53, v147
  v_add_f32 v10, v10, v106
  v_add_f32 v11, v11, v107
  v_fmac_f32 v12, v106, v106
  v_fmac_f32 v13, v107, v107
  ds_read_b128 v[76:79], v5 offset:21504
  ds_read_b128 v[80:83], v5 offset:22528
  ds_read_b128 v[84:87], v5 offset:23552
  s_waitcnt vmcnt(7) lgkmcnt(6)
  v_mfma_f32_32x32x16_bf16 v[16:31], v[88:91], v[148:151], v[16:31]
  buffer_load_dwordx4 v[180:183], v6, s[20:23], s47 offen
  s_add_u32 s47, s47, 65536
  v_lshlrev_b32 v100, 16, v148
  v_and_b32 v101, s53, v148
  v_add_f32 v10, v10, v100
  v_add_f32 v11, v11, v101
  v_fmac_f32 v12, v100, v100
  v_fmac_f32 v13, v101, v101
  v_lshlrev_b32 v106, 16, v149
  v_and_b32 v107, s53, v149
  v_mfma_f32_32x32x16_bf16 v[32:47], v[92:95], v[148:151], v[32:47]
  v_add_f32 v10, v10, v106
  v_add_f32 v11, v11, v107
  v_fmac_f32 v12, v106, v106
  v_fmac_f32 v13, v107, v107
  v_lshlrev_b32 v100, 16, v150
  v_and_b32 v101, s53, v150
  v_add_f32 v10, v10, v100
  v_add_f32 v11, v11, v101
  v_mfma_f32_32x32x16_bf16 v[48:63], v[96:99], v[148:151], v[48:63]
  v_fmac_f32 v12, v100, v100
  v_fmac_f32 v13, v101, v101
  v_lshlrev_b32 v106, 16, v151
  v_and_b32 v107, s53, v151
  v_add_f32 v10, v10, v106
  v_add_f32 v11, v11, v107
  v_fmac_f32 v12, v106, v106
  v_fmac_f32 v13, v107, v107
  ds_read_b128 v[88:91], v5 offset:24576
  ds_read_b128 v[92:95], v5 offset:25600
  ds_read_b128 v[96:99], v5 offset:26624
  s_waitcnt vmcnt(7) lgkmcnt(6)
  v_mfma_f32_32x32x16_bf16 v[16:31], v[64:67], v[152:155], v[16:31]
  buffer_load_dwordx4 v[184:187], v6, s[20:23], s47 offen
  s_add_u32 s47, s47, 65536
  v_lshlrev_b32 v100, 16, v152
  v_and_b32 v101, s53, v152
  v_add_f32 v10, v10, v100
  v_add_f32 v11, v11, v101
  v_fmac_f32 v12, v100, v100
  v_fmac_f32 v13, v101, v101
  v_lshlrev_b32 v106, 16, v153
  v_and_b32 v107, s53, v153
  v_mfma_f32_32x32x16_bf16 v[32:47], v[68:71], v[152:155], v[32:47]
  v_add_f32 v10, v10, v106
  v_add_f32 v11, v11, v107
  v_fmac_f32 v12, v106, v106
  v_fmac_f32 v13, v107, v107
  v_lshlrev_b32 v100, 16, v154
  v_and_b32 v101, s53, v154
  v_add_f32 v10, v10, v100
  v_add_f32 v11, v11, v101
  v_mfma_f32_32x32x16_bf16 v[48:63], v[72:75], v[152:155], v[48:63]
  v_fmac_f32 v12, v100, v100
  v_fmac_f32 v13, v101, v101
  v_lshlrev_b32 v106, 16, v155
  v_and_b32 v107, s53, v155
  v_add_f32 v10, v10, v106
  v_add_f32 v11, v11, v107
  v_fmac_f32 v12, v106, v106
  v_fmac_f32 v13, v107, v107
  ds_read_b128 v[64:67], v5 offset:27648
  ds_read_b128 v[68:71], v5 offset:28672
  ds_read_b128 v[72:75], v5 offset:29696
  s_waitcnt vmcnt(7) lgkmcnt(6)
  v_mfma_f32_32x32x16_bf16 v[16:31], v[76:79], v[156:159], v[16:31]
  buffer_load_dwordx4 v[188:191], v6, s[20:23], s47 offen
  s_add_u32 s47, s47, 65536
  v_lshlrev_b32 v100, 16, v156
  v_and_b32 v101, s53, v156
  v_add_f32 v10, v10, v100
  v_add_f32 v11, v11, v101
  v_fmac_f32 v12, v100, v100
  v_fmac_f32 v13, v101, v101
  v_lshlrev_b32 v106, 16, v157
  v_and_b32 v107, s53, v157
  v_mfma_f32_32x32x16_bf16 v[32:47], v[80:83], v[156:159], v[32:47]
  v_add_f32 v10, v10, v106
  v_add_f32 v11, v11, v107
  v_fmac_f32 v12, v106, v106
  v_fmac_f32 v13, v107, v107
  v_lshlrev_b32 v100, 16, v158
  v_and_b32 v101, s53, v158
  v_add_f32 v10, v10, v100
  v_add_f32 v11, v11, v101
  v_mfma_f32_32x32x16_bf16 v[48:63], v[84:87], v[156:159], v[48:63]
  v_fmac_f32 v12, v100, v100
  v_fmac_f32 v13, v101, v101
  v_lshlrev_b32 v106, 16, v159
  v_and_b32 v107, s53, v159
  v_add_f32 v10, v10, v106
  v_add_f32 v11, v11, v107
  v_fmac_f32 v12, v106, v106
  v_fmac_f32 v13, v107, v107
  ds_read_b128 v[76:79], v5 offset:30720
  ds_read_b128 v[80:83], v5 offset:31744
  ds_read_b128 v[84:87], v5 offset:32768
  s_waitcnt vmcnt(7) lgkmcnt(6)
  v_mfma_f32_32x32x16_bf16 v[16:31], v[88:91], v[160:163], v[16:31]
  buffer_load_dwordx4 v[192:195], v6, s[20:23], s47 offen
  s_add_u32 s47, s47, 65536
  v_lshlrev_b32 v100, 16, v160
  v_and_b32 v101, s53, v160
  v_add_f32 v10, v10, v100
  v_add_f32 v11, v11, v101
  v_fmac_f32 v12, v100, v100
  v_fmac_f32 v13, v101, v101
  v_lshlrev_b32 v106, 16, v161
  v_and_b32 v107, s53, v161
  v_mfma_f32_32x32x16_bf16 v[32:47], v[92:95], v[160:163], v[32:47]
  v_add_f32 v10, v10, v106
  v_add_f32 v11, v11, v107
  v_fmac_f32 v12, v106, v106
  v_fmac_f32 v13, v107, v107
  v_lshlrev_b32 v100, 16, v162
  v_and_b32 v101, s53, v162
  v_add_f32 v10, v10, v100
  v_add_f32 v11, v11, v101
  v_mfma_f32_32x32x16_bf16 v[48:63], v[96:99], v[160:163], v[48:63]
  v_fmac_f32 v12, v100, v100
  v_fmac_f32 v13, v101, v101
  v_lshlrev_b32 v106, 16, v163
  v_and_b32 v107, s53, v163
  v_add_f32 v10, v10, v106
  v_add_f32 v11, v11, v107
  v_fmac_f32 v12, v106, v106
  v_fmac_f32 v13, v107, v107
  ds_read_b128 v[88:91], v5 offset:33792
  ds_read_b128 v[92:95], v5 offset:34816
  ds_read_b128 v[96:99], v5 offset:35840
  s_waitcnt vmcnt(7) lgkmcnt(6)
  v_mfma_f32_32x32x16_bf16 v[16:31], v[64:67], v[164:167], v[16:31]
  buffer_load_dwordx4 v[196:199], v6, s[20:23], s47 offen
  s_add_u32 s47, s47, 65536
  v_lshlrev_b32 v100, 16, v164
  v_and_b32 v101, s53, v164
  v_add_f32 v10, v10, v100
  v_add_f32 v11, v11, v101
  v_fmac_f32 v12, v100, v100
  v_fmac_f32 v13, v101, v101
  v_lshlrev_b32 v106, 16, v165
  v_and_b32 v107, s53, v165
  v_mfma_f32_32x32x16_bf16 v[32:47], v[68:71], v[164:167], v[32:47]
  v_add_f32 v10, v10, v106
  v_add_f32 v11, v11, v107
  v_fmac_f32 v12, v106, v106
  v_fmac_f32 v13, v107, v107
  v_lshlrev_b32 v100, 16, v166
  v_and_b32 v101, s53, v166
  v_add_f32 v10, v10, v100
  v_add_f32 v11, v11, v101
  v_mfma_f32_32x32x16_bf16 v[48:63], v[72:75], v[164:167], v[48:63]
  v_fmac_f32 v12, v100, v100
  v_fmac_f32 v13, v101, v101
  v_lshlrev_b32 v106, 16, v167
  v_and_b32 v107, s53, v167
  v_add_f32 v10, v10, v106
  v_add_f32 v11, v11, v107
  v_fmac_f32 v12, v106, v106
  v_fmac_f32 v13, v107, v107
  ds_read_b128 v[64:67], v5 offset:36864
  ds_read_b128 v[68:71], v5 offset:37888
  ds_read_b128 v[72:75], v5 offset:38912
  s_waitcnt vmcnt(7) lgkmcnt(6)
  v_mfma_f32_32x32x16_bf16 v[16:31], v[76:79], v[168:171], v[16:31]
  buffer_load_dwordx4 v[200:203], v6, s[20:23], s47 offen
  s_add_u32 s47, s47, 65536
  v_lshlrev_b32 v100, 16, v168
  v_and_b32 v101, s53, v168
  v_add_f32 v10, v10, v100
  v_add_f32 v11, v11, v101
  v_fmac_f32 v12, v100, v100
  v_fmac_f32 v13, v101, v101
  v_lshlrev_b32 v106, 16, v169
  v_and_b32 v107, s53, v169
  v_mfma_f32_32x32x16_bf16 v[32:47], v[80:83], v[168:171], v[32:47]
  v_add_f32 v10, v10, v106
  v_add_f32 v11, v11, v107
  v_fmac_f32 v12, v106, v106
  v_fmac_f32 v13, v107, v107
  v_lshlrev_b32 v100, 16, v170
  v_and_b32 v101, s53, v170
  v_add_f32 v10, v10, v100
  v_add_f32 v11, v11, v101
  v_mfma_f32_32x32x16_bf16 v[48:63], v[84:87], v[168:171], v[48:63]
  v_fmac_f32 v12, v100, v100
  v_fmac_f32 v13, v101, v101
  v_lshlrev_b32 v106, 16, v171
  v_and_b32 v107, s53, v171
  v_add_f32 v10, v10, v106
  v_add_f32 v11, v11, v107
  v_fmac_f32 v12, v106, v106
  v_fmac_f32 v13, v107, v107
  ds_read_b128 v[76:79], v5 offset:39936
  ds_read_b128 v[80:83], v5 offset:40960
  ds_read_b128 v[84:87], v5 offset:41984
  s_waitcnt vmcnt(7) lgkmcnt(6)
  v_mfma_f32_32x32x16_bf16 v[16:31], v[88:91], v[172:175], v[16:31]
  buffer_load_dwordx4 v[204:207], v6, s[20:23], s47 offen
  s_add_u32 s47, s47, 65536
  v_lshlrev_b32 v100, 16, v172
  v_and_b32 v101, s53, v172
  v_add_f32 v10, v10, v100
  v_add_f32 v11, v11, v101
  v_fmac_f32 v12, v100, v100
  v_fmac_f32 v13, v101, v101
  v_lshlrev_b32 v106, 16, v173
  v_and_b32 v107, s53, v173
  v_mfma_f32_32x32x16_bf16 v[32:47], v[92:95], v[172:175], v[32:47]
  v_add_f32 v10, v10, v106
  v_add_f32 v11, v11, v107
  v_fmac_f32 v12, v106, v106
  v_fmac_f32 v13, v107, v107
  v_lshlrev_b32 v100, 16, v174
  v_and_b32 v101, s53, v174
  v_add_f32 v10, v10, v100
  v_add_f32 v11, v11, v101
  v_mfma_f32_32x32x16_bf16 v[48:63], v[96:99], v[172:175], v[48:63]
  v_fmac_f32 v12, v100, v100
  v_fmac_f32 v13, v101, v101
  v_lshlrev_b32 v106, 16, v175
  v_and_b32 v107, s53, v175
  v_add_f32 v10, v10, v106
  v_add_f32 v11, v11, v107
  v_fmac_f32 v12, v106, v106
  v_fmac_f32 v13, v107, v107
  ds_read_b128 v[88:91], v5 offset:43008
  ds_read_b128 v[92:95], v5 offset:44032
  ds_read_b128 v[96:99], v5 offset:45056
  s_waitcnt vmcnt(7) lgkmcnt(6)
  v_mfma_f32_32x32x16_bf16 v[16:31], v[64:67], v[176:179], v[16:31]
  buffer_load_dwordx4 v[208:211], v6, s[20:23], s47 offen
  s_add_u32 s47, s47, 65536
  v_lshlrev_b32 v100, 16, v176
  v_and_b32 v101, s53, v176
  v_add_f32 v10, v10, v100
  v_add_f32 v11, v11, v101
  v_fmac_f32 v12, v100, v100
  v_fmac_f32 v13, v101, v101
  v_lshlrev_b32 v106, 16, v177
  v_and_b32 v107, s53, v177
  v_mfma_f32_32x32x16_bf16 v[32:47], v[68:71], v[176:179], v[32:47]
  v_add_f32 v10, v10, v106
  v_add_f32 v11, v11, v107
  v_fmac_f32 v12, v106, v106
  v_fmac_f32 v13, v107, v107
  v_lshlrev_b32 v100, 16, v178
  v_and_b32 v101, s53, v178
  v_add_f32 v10, v10, v100
  v_add_f32 v11, v11, v101
  v_mfma_f32_32x32x16_bf16 v[48:63], v[72:75], v[176:179], v[48:63]
  v_fmac_f32 v12, v100, v100
  v_fmac_f32 v13, v101, v101
  v_lshlrev_b32 v106, 16, v179
  v_and_b32 v107, s53, v179
  v_add_f32 v10, v10, v106
  v_add_f32 v11, v11, v107
  v_fmac_f32 v12, v106, v106
  v_fmac_f32 v13, v107, v107
  ds_read_b128 v[64:67], v5 offset:46080
  ds_read_b128 v[68:71], v5 offset:47104
  ds_read_b128 v[72:75], v5 offset:48128
  s_waitcnt vmcnt(7) lgkmcnt(6)
  v_mfma_f32_32x32x16_bf16 v[16:31], v[76:79], v[180:183], v[16:31]
  buffer_load_dwordx4 v[212:215], v6, s[20:23], s47 offen
  s_add_u32 s47, s47, 65536
  v_lshlrev_b32 v100, 16, v180
  v_and_b32 v101, s53, v180
  v_add_f32 v10, v10, v100
  v_add_f32 v11, v11, v101
  v_fmac_f32 v12, v100, v100
  v_fmac_f32 v13, v101, v101
  v_lshlrev_b32 v106, 16, v181
  v_and_b32 v107, s53, v181
  v_mfma_f32_32x32x16_bf16 v[32:47], v[80:83], v[180:183], v[32:47]
  v_add_f32 v10, v10, v106
  v_add_f32 v11, v11, v107
  v_fmac_f32 v12, v106, v106
  v_fmac_f32 v13, v107, v107
  v_lshlrev_b32 v100, 16, v182
  v_and_b32 v101, s53, v182
  v_add_f32 v10, v10, v100
  v_add_f32 v11, v11, v101
  v_mfma_f32_32x32x16_bf16 v[48:63], v[84:87], v[180:183], v[48:63]
  v_fmac_f32 v12, v100, v100
  v_fmac_f32 v13, v101, v101
  v_lshlrev_b32 v106, 16, v183
  v_and_b32 v107, s53, v183
  v_add_f32 v10, v10, v106
  v_add_f32 v11, v11, v107
  v_fmac_f32 v12, v106, v106
  v_fmac_f32 v13, v107, v107
  ds_read_b128 v[76:79], v9 offset:0
  ds_read_b128 v[80:83], v9 offset:1024
  ds_read_b128 v[84:87], v9 offset:2048
  s_waitcnt vmcnt(7) lgkmcnt(6)
  v_mfma_f32_32x32x16_bf16 v[16:31], v[88:91], v[184:187], v[16:31]
  buffer_load_dwordx4 v[216:219], v6, s[20:23], s47 offen
  s_add_u32 s47, s47, 65536
  v_lshlrev_b32 v100, 16, v184
  v_and_b32 v101, s53, v184
  v_add_f32 v10, v10, v100
  v_add_f32 v11, v11, v101
  v_fmac_f32 v12, v100, v100
  v_fmac_f32 v13, v101, v101
  v_lshlrev_b32 v106, 16, v185
  v_and_b32 v107, s53, v185
  v_mfma_f32_32x32x16_bf16 v[32:47], v[92:95], v[184:187], v[32:47]
  v_add_f32 v10, v10, v106
  v_add_f32 v11, v11, v107
  v_fmac_f32 v12, v106, v106
  v_fmac_f32 v13, v107, v107
  v_lshlrev_b32 v100, 16, v186
  v_and_b32 v101, s53, v186
  v_add_f32 v10, v10, v100
  v_add_f32 v11, v11, v101
  v_mfma_f32_32x32x16_bf16 v[48:63], v[96:99], v[184:187], v[48:63]
  v_fmac_f32 v12, v100, v100
  v_fmac_f32 v13, v101, v101
  v_lshlrev_b32 v106, 16, v187
  v_and_b32 v107, s53, v187
  v_add_f32 v10, v10, v106
  v_add_f32 v11, v11, v107
  v_fmac_f32 v12, v106, v106
  v_fmac_f32 v13, v107, v107
  ds_read_b128 v[88:91], v9 offset:3072
  ds_read_b128 v[92:95], v9 offset:4096
  ds_read_b128 v[96:99], v9 offset:5120
  s_waitcnt vmcnt(7) lgkmcnt(6)
  v_mfma_f32_32x32x16_bf16 v[16:31], v[64:67], v[188:191], v[16:31]
  buffer_load_dwordx4 v[220:223], v6, s[20:23], s47 offen
  s_add_u32 s47, s47, 65536
  v_lshlrev_b32 v100, 16, v188
  v_and_b32 v101, s53, v188
  v_add_f32 v10, v10, v100
  v_add_f32 v11, v11, v101
  v_fmac_f32 v12, v100, v100
  v_fmac_f32 v13, v101, v101
  v_lshlrev_b32 v106, 16, v189
  v_and_b32 v107, s53, v189
  v_mfma_f32_32x32x16_bf16 v[32:47], v[68:71], v[188:191], v[32:47]
  v_add_f32 v10, v10, v106
  v_add_f32 v11, v11, v107
  v_fmac_f32 v12, v106, v106
  v_fmac_f32 v13, v107, v107
  v_lshlrev_b32 v100, 16, v190
  v_and_b32 v101, s53, v190
  v_add_f32 v10, v10, v100
  v_add_f32 v11, v11, v101
  v_mfma_f32_32x32x16_bf16 v[48:63], v[72:75], v[188:191], v[48:63]
  v_fmac_f32 v12, v100, v100
  v_fmac_f32 v13, v101, v101
  v_lshlrev_b32 v106, 16, v191
  v_and_b32 v107, s53, v191
  v_add_f32 v10, v10, v106
  v_add_f32 v11, v11, v107
  v_fmac_f32 v12, v106, v106
  v_fmac_f32 v13, v107, v107
  ds_read_b128 v[64:67], v9 offset:6144
  ds_read_b128 v[68:71], v9 offset:7168
  ds_read_b128 v[72:75], v9 offset:8192
  s_waitcnt vmcnt(7) lgkmcnt(6)
  v_mfma_f32_32x32x16_bf16 v[16:31], v[76:79], v[192:195], v[16:31]
  buffer_load_dwordx4 v[224:227], v6, s[20:23], s47 offen
  s_add_u32 s47, s47, 65536
  v_lshlrev_b32 v100, 16, v192
  v_and_b32 v101, s53, v192
  v_add_f32 v10, v10, v100
  v_add_f32 v11, v11, v101
  v_fmac_f32 v12, v100, v100
  v_fmac_f32 v13, v101, v101
  v_lshlrev_b32 v106, 16, v193
  v_and_b32 v107, s53, v193
  v_mfma_f32_32x32x16_bf16 v[32:47], v[80:83], v[192:195], v[32:47]
  v_add_f32 v10, v10, v106
  v_add_f32 v11, v11, v107
  v_fmac_f32 v12, v106, v106
  v_fmac_f32 v13, v107, v107
  v_lshlrev_b32 v100, 16, v194
  v_and_b32 v101, s53, v194
  v_add_f32 v10, v10, v100
  v_add_f32 v11, v11, v101
  v_mfma_f32_32x32x16_bf16 v[48:63], v[84:87], v[192:195], v[48:63]
  v_fmac_f32 v12, v100, v100
  v_fmac_f32 v13, v101, v101
  v_lshlrev_b32 v106, 16, v195
  v_and_b32 v107, s53, v195
  v_add_f32 v10, v10, v106
  v_add_f32 v11, v11, v107
  v_fmac_f32 v12, v106, v106
  v_fmac_f32 v13, v107, v107
  ds_read_b128 v[76:79], v9 offset:9216
  ds_read_b128 v[80:83], v9 offset:10240
  ds_read_b128 v[84:87], v9 offset:11264
  s_waitcnt vmcnt(7) lgkmcnt(6)
  v_mfma_f32_32x32x16_bf16 v[16:31], v[88:91], v[196:199], v[16:31]
  buffer_load_dwordx4 v[228:231], v6, s[20:23], s47 offen
  s_add_u32 s47, s47, 65536
  v_lshlrev_b32 v100, 16, v196
  v_and_b32 v101, s53, v196
  v_add_f32 v10, v10, v100
  v_add_f32 v11, v11, v101
  v_fmac_f32 v12, v100, v100
  v_fmac_f32 v13, v101, v101
  v_lshlrev_b32 v106, 16, v197
  v_and_b32 v107, s53, v197
  v_mfma_f32_32x32x16_bf16 v[32:47], v[92:95], v[196:199], v[32:47]
  v_add_f32 v10, v10, v106
  v_add_f32 v11, v11, v107
  v_fmac_f32 v12, v106, v106
  v_fmac_f32 v13, v107, v107
  v_lshlrev_b32 v100, 16, v198
  v_and_b32 v101, s53, v198
  v_add_f32 v10, v10, v100
  v_add_f32 v11, v11, v101
  v_mfma_f32_32x32x16_bf16 v[48:63], v[96:99], v[196:199], v[48:63]
  v_fmac_f32 v12, v100, v100
  v_fmac_f32 v13, v101, v101
  v_lshlrev_b32 v106, 16, v199
  v_and_b32 v107, s53, v199
  v_add_f32 v10, v10, v106
  v_add_f32 v11, v11, v107
  v_fmac_f32 v12, v106, v106
  v_fmac_f32 v13, v107, v107
  ds_read_b128 v[88:91], v9 offset:12288
  ds_read_b128 v[92:95], v9 offset:13312
  ds_read_b128 v[96:99], v9 offset:14336
  s_waitcnt vmcnt(7) lgkmcnt(6)
  v_mfma_f32_32x32x16_bf16 v[16:31], v[64:67], v[200:203], v[16:31]
  buffer_load_dwordx4 v[232:235], v6, s[20:23], s47 offen
  s_add_u32 s47, s47, 65536
  v_lshlrev_b32 v100, 16, v200
  v_and_b32 v101, s53, v200
  v_add_f32 v10, v10, v100
  v_add_f32 v11, v11, v101
  v_fmac_f32 v12, v100, v100
  v_fmac_f32 v13, v101, v101
  v_lshlrev_b32 v106, 16, v201
  v_and_b32 v107, s53, v201
  v_mfma_f32_32x32x16_bf16 v[32:47], v[68:71], v[200:203], v[32:47]
  v_add_f32 v10, v10, v106
  v_add_f32 v11, v11, v107
  v_fmac_f32 v12, v106, v106
  v_fmac_f32 v13, v107, v107
  v_lshlrev_b32 v100, 16, v202
  v_and_b32 v101, s53, v202
  v_add_f32 v10, v10, v100
  v_add_f32 v11, v11, v101
  v_mfma_f32_32x32x16_bf16 v[48:63], v[72:75], v[200:203], v[48:63]
  v_fmac_f32 v12, v100, v100
  v_fmac_f32 v13, v101, v101
  v_lshlrev_b32 v106, 16, v203
  v_and_b32 v107, s53, v203
  v_add_f32 v10, v10, v106
  v_add_f32 v11, v11, v107
  v_fmac_f32 v12, v106, v106
  v_fmac_f32 v13, v107, v107
  ds_read_b128 v[64:67], v9 offset:15360
  ds_read_b128 v[68:71], v9 offset:16384
  ds_read_b128 v[72:75], v9 offset:17408
  s_waitcnt vmcnt(7) lgkmcnt(6)
  v_mfma_f32_32x32x16_bf16 v[16:31], v[76:79], v[204:207], v[16:31]
  buffer_load_dwordx4 v[236:239], v6, s[20:23], s47 offen
  s_add_u32 s47, s47, 65536
  v_lshlrev_b32 v100, 16, v204
  v_and_b32 v101, s53, v204
  v_add_f32 v10, v10, v100
  v_add_f32 v11, v11, v101
  v_fmac_f32 v12, v100, v100
  v_fmac_f32 v13, v101, v101
  v_lshlrev_b32 v106, 16, v205
  v_and_b32 v107, s53, v205
  v_mfma_f32_32x32x16_bf16 v[32:47], v[80:83], v[204:207], v[32:47]
  v_add_f32 v10, v10, v106
  v_add_f32 v11, v11, v107
  v_fmac_f32 v12, v106, v106
  v_fmac_f32 v13, v107, v107
  v_lshlrev_b32 v100, 16, v206
  v_and_b32 v101, s53, v206
  v_add_f32 v10, v10, v100
  v_add_f32 v11, v11, v101
  v_mfma_f32_32x32x16_bf16 v[48:63], v[84:87], v[204:207], v[48:63]
  v_fmac_f32 v12, v100, v100
  v_fmac_f32 v13, v101, v101
  v_lshlrev_b32 v106, 16, v207
  v_and_b32 v107, s53, v207
  v_add_f32 v10, v10, v106
  v_add_f32 v11, v11, v107
  v_fmac_f32 v12, v106, v106
  v_fmac_f32 v13, v107, v107
  ds_read_b128 v[76:79], v9 offset:18432
  ds_read_b128 v[80:83], v9 offset:19456
  ds_read_b128 v[84:87], v9 offset:20480
  s_waitcnt vmcnt(7) lgkmcnt(6)
  v_mfma_f32_32x32x16_bf16 v[16:31], v[88:91], v[208:211], v[16:31]
  buffer_load_dwordx4 v[240:243], v6, s[20:23], s47 offen
  s_add_u32 s47, s47, 65536
  v_lshlrev_b32 v100, 16, v208
  v_and_b32 v101, s53, v208
  v_add_f32 v10, v10, v100
  v_add_f32 v11, v11, v101
  v_fmac_f32 v12, v100, v100
  v_fmac_f32 v13, v101, v101
  v_lshlrev_b32 v106, 16, v209
  v_and_b32 v107, s53, v209
  v_mfma_f32_32x32x16_bf16 v[32:47], v[92:95], v[208:211], v[32:47]
  v_add_f32 v10, v10, v106
  v_add_f32 v11, v11, v107
  v_fmac_f32 v12, v106, v106
  v_fmac_f32 v13, v107, v107
  v_lshlrev_b32 v100, 16, v210
  v_and_b32 v101, s53, v210
  v_add_f32 v10, v10, v100
  v_add_f32 v11, v11, v101
  v_mfma_f32_32x32x16_bf16 v[48:63], v[96:99], v[208:211], v[48:63]
  v_fmac_f32 v12, v100, v100
  v_fmac_f32 v13, v101, v101
  v_lshlrev_b32 v106, 16, v211
  v_and_b32 v107, s53, v211
  v_add_f32 v10, v10, v106
  v_add_f32 v11, v11, v107
  v_fmac_f32 v12, v106, v106
  v_fmac_f32 v13, v107, v107
  ds_read_b128 v[88:91], v9 offset:21504
  ds_read_b128 v[92:95], v9 offset:22528
  ds_read_b128 v[96:99], v9 offset:23552
  s_waitcnt vmcnt(7) lgkmcnt(6)
  v_mfma_f32_32x32x16_bf16 v[16:31], v[64:67], v[212:215], v[16:31]
  buffer_load_dwordx4 v[244:247], v6, s[20:23], s47 offen
  s_add_u32 s47, s47, 65536
  v_lshlrev_b32 v100, 16, v212
  v_and_b32 v101, s53, v212
  v_add_f32 v10, v10, v100
  v_add_f32 v11, v11, v101
  v_fmac_f32 v12, v100, v100
  v_fmac_f32 v13, v101, v101
  v_lshlrev_b32 v106, 16, v213
  v_and_b32 v107, s53, v213
  v_mfma_f32_32x32x16_bf16 v[32:47], v[68:71], v[212:215], v[32:47]
  v_add_f32 v10, v10, v106
  v_add_f32 v11, v11, v107
  v_fmac_f32 v12, v106, v106
  v_fmac_f32 v13, v107, v107
  v_lshlrev_b32 v100, 16, v214
  v_and_b32 v101, s53, v214
  v_add_f32 v10, v10, v100
  v_add_f32 v11, v11, v101
  v_mfma_f32_32x32x16_bf16 v[48:63], v[72:75], v[212:215], v[48:63]
  v_fmac_f32 v12, v100, v100
  v_fmac_f32 v13, v101, v101
  v_lshlrev_b32 v106, 16, v215
  v_and_b32 v107, s53, v215
  v_add_f32 v10, v10, v106
  v_add_f32 v11, v11, v107
  v_fmac_f32 v12, v106, v106
  v_fmac_f32 v13, v107, v107
  ds_read_b128 v[64:67], v9 offset:24576
  ds_read_b128 v[68:71], v9 offset:25600
  ds_read_b128 v[72:75], v9 offset:26624
  s_waitcnt vmcnt(7) lgkmcnt(6)
  v_mfma_f32_32x32x16_bf16 v[16:31], v[76:79], v[216:219], v[16:31]
  buffer_load_dwordx4 v[248:251], v6, s[20:23], s47 offen
  s_add_u32 s47, s47, 65536
  v_lshlrev_b32 v100, 16, v216
  v_and_b32 v101, s53, v216
  v_add_f32 v10, v10, v100
  v_add_f32 v11, v11, v101
  v_fmac_f32 v12, v100, v100
  v_fmac_f32 v13, v101, v101
  v_lshlrev_b32 v106, 16, v217
  v_and_b32 v107, s53, v217
  v_mfma_f32_32x32x16_bf16 v[32:47], v[80:83], v[216:219], v[32:47]
  v_add_f32 v10, v10, v106
  v_add_f32 v11, v11, v107
  v_fmac_f32 v12, v106, v106
  v_fmac_f32 v13, v107, v107
  v_lshlrev_b32 v100, 16, v218
  v_and_b32 v101, s53, v218
  v_add_f32 v10, v10, v100
  v_add_f32 v11, v11, v101
  v_mfma_f32_32x32x16_bf16 v[48:63], v[84:87], v[216:219], v[48:63]
  v_fmac_f32 v12, v100, v100
  v_fmac_f32 v13, v101, v101
  v_lshlrev_b32 v106, 16, v219
  v_and_b32 v107, s53, v219
  v_add_f32 v10, v10, v106
  v_add_f32 v11, v11, v107
  v_fmac_f32 v12, v106, v106
  v_fmac_f32 v13, v107, v107
  ds_read_b128 v[76:79], v9 offset:27648
  ds_read_b128 v[80:83], v9 offset:28672
  ds_read_b128 v[84:87], v9 offset:29696
  s_waitcnt vmcnt(7) lgkmcnt(6)
  v_mfma_f32_32x32x16_bf16 v[16:31], v[88:91], v[220:223], v[16:31]
  buffer_load_dwordx4 v[252:255], v6, s[20:23], s47 offen
  s_add_u32 s47, s47, 65536
  v_lshlrev_b32 v100, 16, v220
  v_and_b32 v101, s53, v220
  v_add_f32 v10, v10, v100
  v_add_f32 v11, v11, v101
  v_fmac_f32 v12, v100, v100
  v_fmac_f32 v13, v101, v101
  v_lshlrev_b32 v106, 16, v221
  v_and_b32 v107, s53, v221
  v_mfma_f32_32x32x16_bf16 v[32:47], v[92:95], v[220:223], v[32:47]
  v_add_f32 v10, v10, v106
  v_add_f32 v11, v11, v107
  v_fmac_f32 v12, v106, v106
  v_fmac_f32 v13, v107, v107
  v_lshlrev_b32 v100, 16, v222
  v_and_b32 v101, s53, v222
  v_add_f32 v10, v10, v100
  v_add_f32 v11, v11, v101
  v_mfma_f32_32x32x16_bf16 v[48:63], v[96:99], v[220:223], v[48:63]
  v_fmac_f32 v12, v100, v100
  v_fmac_f32 v13, v101, v101
  v_lshlrev_b32 v106, 16, v223
  v_and_b32 v107, s53, v223
  v_add_f32 v10, v10, v106
  v_add_f32 v11, v11, v107
  v_fmac_f32 v12, v106, v106
  v_fmac_f32 v13, v107, v107
  ds_read_b128 v[88:91], v9 offset:30720
  ds_read_b128 v[92:95], v9 offset:31744
  ds_read_b128 v[96:99], v9 offset:32768
  s_waitcnt vmcnt(7) lgkmcnt(6)
  v_mfma_f32_32x32x16_bf16 v[16:31], v[64:67], v[224:227], v[16:31]
  v_lshlrev_b32 v100, 16, v224
  v_and_b32 v101, s53, v224
  v_add_f32 v10, v10, v100
  v_add_f32 v11, v11, v101
  v_fmac_f32 v12, v100, v100
  v_fmac_f32 v13, v101, v101
  v_lshlrev_b32 v106, 16, v225
  v_and_b32 v107, s53, v225
  v_mfma_f32_32x32x16_bf16 v[32:47], v[68:71], v[224:227], v[32:47]
  v_add_f32 v10, v10, v106
  v_add_f32 v11, v11, v107
  v_fmac_f32 v12, v106, v106
  v_fmac_f32 v13, v107, v107
  v_lshlrev_b32 v100, 16, v226
  v_and_b32 v101, s53, v226
  v_add_f32 v10, v10, v100
  v_add_f32 v11, v11, v101
  v_mfma_f32_32x32x16_bf16 v[48:63], v[72:75], v[224:227], v[48:63]
  v_fmac_f32 v12, v100, v100
  v_fmac_f32 v13, v101, v101
  v_lshlrev_b32 v106, 16, v227
  v_and_b32 v107, s53, v227
  v_add_f32 v10, v10, v106
  v_add_f32 v11, v11, v107
  v_fmac_f32 v12, v106, v106
  v_fmac_f32 v13, v107, v107
  ds_read_b128 v[64:67], v9 offset:33792
  ds_read_b128 v[68:71], v9 offset:34816
  ds_read_b128 v[72:75], v9 offset:35840
  s_waitcnt vmcnt(6) lgkmcnt(6)
  v_mfma_f32_32x32x16_bf16 v[16:31], v[76:79], v[228:231], v[16:31]
  v_lshlrev_b32 v100, 16, v228
  v_and_b32 v101, s53, v228
  v_add_f32 v10, v10, v100
  v_add_f32 v11, v11, v101
  v_fmac_f32 v12, v100, v100
  v_fmac_f32 v13, v101, v101
  v_lshlrev_b32 v106, 16, v229
  v_and_b32 v107, s53, v229
  v_mfma_f32_32x32x16_bf16 v[32:47], v[80:83], v[228:231], v[32:47]
  v_add_f32 v10, v10, v106
  v_add_f32 v11, v11, v107
  v_fmac_f32 v12, v106, v106
  v_fmac_f32 v13, v107, v107
  v_lshlrev_b32 v100, 16, v230
  v_and_b32 v101, s53, v230
  v_add_f32 v10, v10, v100
  v_add_f32 v11, v11, v101
  v_mfma_f32_32x32x16_bf16 v[48:63], v[84:87], v[228:231], v[48:63]
  v_fmac_f32 v12, v100, v100
  v_fmac_f32 v13, v101, v101
  v_lshlrev_b32 v106, 16, v231
  v_and_b32 v107, s53, v231
  v_add_f32 v10, v10, v106
  v_add_f32 v11, v11, v107
  v_fmac_f32 v12, v106, v106
  v_fmac_f32 v13, v107, v107
  ds_read_b128 v[76:79], v9 offset:36864
  ds_read_b128 v[80:83], v9 offset:37888
  ds_read_b128 v[84:87], v9 offset:38912
  s_waitcnt vmcnt(5) lgkmcnt(6)
  v_mfma_f32_32x32x16_bf16 v[16:31], v[88:91], v[232:235], v[16:31]
  v_lshlrev_b32 v100, 16, v232
  v_and_b32 v101, s53, v232
  v_add_f32 v10, v10, v100
  v_add_f32 v11, v11, v101
  v_fmac_f32 v12, v100, v100
  v_fmac_f32 v13, v101, v101
  v_lshlrev_b32 v106, 16, v233
  v_and_b32 v107, s53, v233
  v_mfma_f32_32x32x16_bf16 v[32:47], v[92:95], v[232:235], v[32:47]
  v_add_f32 v10, v10, v106
  v_add_f32 v11, v11, v107
  v_fmac_f32 v12, v106, v106
  v_fmac_f32 v13, v107, v107
  v_lshlrev_b32 v100, 16, v234
  v_and_b32 v101, s53, v234
  v_add_f32 v10, v10, v100
  v_add_f32 v11, v11, v101
  v_mfma_f32_32x32x16_bf16 v[48:63], v[96:99], v[232:235], v[48:63]
  v_fmac_f32 v12, v100, v100
  v_fmac_f32 v13, v101, v101
  v_lshlrev_b32 v106, 16, v235
  v_and_b32 v107, s53, v235
  v_add_f32 v10, v10, v106
  v_add_f32 v11, v11, v107
  v_fmac_f32 v12, v106, v106
  v_fmac_f32 v13, v107, v107
  ds_read_b128 v[88:91], v9 offset:39936
  ds_read_b128 v[92:95], v9 offset:40960
  ds_read_b128 v[96:99], v9 offset:41984
  s_waitcnt vmcnt(4) lgkmcnt(6)
  v_mfma_f32_32x32x16_bf16 v[16:31], v[64:67], v[236:239], v[16:31]
  v_lshlrev_b32 v100, 16, v236
  v_and_b32 v101, s53, v236
  v_add_f32 v10, v10, v100
  v_add_f32 v11, v11, v101
  v_fmac_f32 v12, v100, v100
  v_fmac_f32 v13, v101, v101
  v_lshlrev_b32 v106, 16, v237
  v_and_b32 v107, s53, v237
  v_mfma_f32_32x32x16_bf16 v[32:47], v[68:71], v[236:239], v[32:47]
  v_add_f32 v10, v10, v106
  v_add_f32 v11, v11, v107
  v_fmac_f32 v12, v106, v106
  v_fmac_f32 v13, v107, v107
  v_lshlrev_b32 v100, 16, v238
  v_and_b32 v101, s53, v238
  v_add_f32 v10, v10, v100
  v_add_f32 v11, v11, v101
  v_mfma_f32_32x32x16_bf16 v[48:63], v[72:75], v[236:239], v[48:63]
  v_fmac_f32 v12, v100, v100
  v_fmac_f32 v13, v101, v101
  v_lshlrev_b32 v106, 16, v239
  v_and_b32 v107, s53, v239
  v_add_f32 v10, v10, v106
  v_add_f32 v11, v11, v107
  v_fmac_f32 v12, v106, v106
  v_fmac_f32 v13, v107, v107
  ds_read_b128 v[64:67], v9 offset:43008
  ds_read_b128 v[68:71], v9 offset:44032
  ds_read_b128 v[72:75], v9 offset:45056
  s_waitcnt vmcnt(3) lgkmcnt(6)
  v_mfma_f32_32x32x16_bf16 v[16:31], v[76:79], v[240:243], v[16:31]
  v_lshlrev_b32 v100, 16, v240
  v_and_b32 v101, s53, v240
  v_add_f32 v10, v10, v100
  v_add_f32 v11, v11, v101
  v_fmac_f32 v12, v100, v100
  v_fmac_f32 v13, v101, v101
  v_lshlrev_b32 v106, 16, v241
  v_and_b32 v107, s53, v241
  v_mfma_f32_32x32x16_bf16 v[32:47], v[80:83], v[240:243], v[32:47]
  v_add_f32 v10, v10, v106
  v_add_f32 v11, v11, v107
  v_fmac_f32 v12, v106, v106
  v_fmac_f32 v13, v107, v107
  v_lshlrev_b32 v100, 16, v242
  v_and_b32 v101, s53, v242
  v_add_f32 v10, v10, v100
  v_add_f32 v11, v11, v101
  v_mfma_f32_32x32x16_bf16 v[48:63], v[84:87], v[240:243], v[48:63]
  v_fmac_f32 v12, v100, v100
  v_fmac_f32 v13, v101, v101
  v_lshlrev_b32 v106, 16, v243
  v_and_b32 v107, s53, v243
  v_add_f32 v10, v10, v106
  v_add_f32 v11, v11, v107
  v_fmac_f32 v12, v106, v106
  v_fmac_f32 v13, v107, v107
  ds_read_b128 v[76:79], v9 offset:46080
  ds_read_b128 v[80:83], v9 offset:47104
  ds_read_b128 v[84:87], v9 offset:48128
  s_waitcnt vmcnt(2) lgkmcnt(6)
  v_mfma_f32_32x32x16_bf16 v[16:31], v[88:91], v[244:247], v[16:31]
  v_lshlrev_b32 v100, 16, v244
  v_and_b32 v101, s53, v244
  v_add_f32 v10, v10, v100
  v_add_f32 v11, v11, v101
  v_fmac_f32 v12, v100, v100
  v_fmac_f32 v13, v101, v101
  v_lshlrev_b32 v106, 16, v245
  v_and_b32 v107, s53, v245
  v_mfma_f32_32x32x16_bf16 v[32:47], v[92:95], v[244:247], v[32:47]
  v_add_f32 v10, v10, v106
  v_add_f32 v11, v11, v107
  v_fmac_f32 v12, v106, v106
  v_fmac_f32 v13, v107, v107
  v_lshlrev_b32 v100, 16, v246
  v_and_b32 v101, s53, v246
  v_add_f32 v10, v10, v100
  v_add_f32 v11, v11, v101
  v_mfma_f32_32x32x16_bf16 v[48:63], v[96:99], v[244:247], v[48:63]
  v_fmac_f32 v12, v100, v100
  v_fmac_f32 v13, v101, v101
  v_lshlrev_b32 v106, 16, v247
  v_and_b32 v107, s53, v247
  v_add_f32 v10, v10, v106
  v_add_f32 v11, v11, v107
  v_fmac_f32 v12, v106, v106
  v_fmac_f32 v13, v107, v107
  s_waitcnt vmcnt(1) lgkmcnt(3)
  v_mfma_f32_32x32x16_bf16 v[16:31], v[64:67], v[248:251], v[16:31]
  v_lshlrev_b32 v100, 16, v248
  v_and_b32 v101, s53, v248
  v_add_f32 v10, v10, v100
  v_add_f32 v11, v11, v101
  v_fmac_f32 v12, v100, v100
  v_fmac_f32 v13, v101, v101
  v_lshlrev_b32 v106, 16, v249
  v_and_b32 v107, s53, v249
  v_mfma_f32_32x32x16_bf16 v[32:47], v[68:71], v[248:251], v[32:47]
  v_add_f32 v10, v10, v106
  v_add_f32 v11, v11, v107
  v_fmac_f32 v12, v106, v106
  v_fmac_f32 v13, v107, v107
  v_lshlrev_b32 v100, 16, v250
  v_and_b32 v101, s53, v250
  v_add_f32 v10, v10, v100
  v_add_f32 v11, v11, v101
  v_mfma_f32_32x32x16_bf16 v[48:63], v[72:75], v[248:251], v[48:63]
  v_fmac_f32 v12, v100, v100
  v_fmac_f32 v13, v101, v101
  v_lshlrev_b32 v106, 16, v251
  v_and_b32 v107, s53, v251
  v_add_f32 v10, v10, v106
  v_add_f32 v11, v11, v107
  v_fmac_f32 v12, v106, v106
  v_fmac_f32 v13, v107, v107
  s_waitcnt vmcnt(0) lgkmcnt(0)
  v_mfma_f32_32x32x16_bf16 v[16:31], v[76:79], v[252:255], v[16:31]
  v_lshlrev_b32 v100, 16, v252
  v_and_b32 v101, s53, v252
  v_add_f32 v10, v10, v100
  v_add_f32 v11, v11, v101
  v_fmac_f32 v12, v100, v100
  v_fmac_f32 v13, v101, v101
  v_lshlrev_b32 v106, 16, v253
  v_and_b32 v107, s53, v253
  v_mfma_f32_32x32x16_bf16 v[32:47], v[80:83], v[252:255], v[32:47]
  v_add_f32 v10, v10, v106
  v_add_f32 v11, v11, v107
  v_fmac_f32 v12, v106, v106
  v_fmac_f32 v13, v107, v107
  v_lshlrev_b32 v100, 16, v254
  v_and_b32 v101, s53, v254
  v_add_f32 v10, v10, v100
  v_add_f32 v11, v11, v101
  v_mfma_f32_32x32x16_bf16 v[48:63], v[84:87], v[252:255], v[48:63]
  v_fmac_f32 v12, v100, v100
  v_fmac_f32 v13, v101, v101
  v_lshlrev_b32 v106, 16, v255
  v_and_b32 v107, s53, v255
  v_add_f32 v10, v10, v106
  v_add_f32 v11, v11, v107
  v_fmac_f32 v12, v106, v106
  v_fmac_f32 v13, v107, v107
  v_accvgpr_read_b32 v128, a128
  v_accvgpr_read_b32 v129, a129
  v_accvgpr_read_b32 v130, a130
  v_accvgpr_read_b32 v131, a131
  v_accvgpr_read_b32 v132, a132
  v_accvgpr_read_b32 v133, a133
  v_accvgpr_read_b32 v134, a134
  v_accvgpr_read_b32 v135, a135
  v_accvgpr_read_b32 v136, a136
  v_accvgpr_read_b32 v137, a137
  v_accvgpr_read_b32 v138, a138
  v_accvgpr_read_b32 v139, a139
  v_accvgpr_read_b32 v140, a140
  v_accvgpr_read_b32 v141, a141
  v_accvgpr_read_b32 v142, a142
  v_accvgpr_read_b32 v143, a143
  v_accvgpr_read_b32 v144, a144
  v_accvgpr_read_b32 v145, a145
  v_accvgpr_read_b32 v146, a146
  v_accvgpr_read_b32 v147, a147
  v_accvgpr_read_b32 v148, a148
  v_accvgpr_read_b32 v149, a149
  v_accvgpr_read_b32 v150, a150
  v_accvgpr_read_b32 v151, a151
  v_accvgpr_read_b32 v152, a152
  v_accvgpr_read_b32 v153, a153
  v_accvgpr_read_b32 v154, a154
  v_accvgpr_read_b32 v155, a155
  v_accvgpr_read_b32 v156, a156
  v_accvgpr_read_b32 v157, a157
  v_accvgpr_read_b32 v158, a158
  v_accvgpr_read_b32 v159, a159
  v_accvgpr_read_b32 v160, a160
  v_accvgpr_read_b32 v161, a161
  v_accvgpr_read_b32 v162, a162
  v_accvgpr_read_b32 v163, a163
  v_accvgpr_read_b32 v164, a164
  v_accvgpr_read_b32 v165, a165
  v_accvgpr_read_b32 v166, a166
  v_accvgpr_read_b32 v167, a167
  v_accvgpr_read_b32 v168, a168
  v_accvgpr_read_b32 v169, a169
  v_accvgpr_read_b32 v170, a170
  v_accvgpr_read_b32 v171, a171
  v_accvgpr_read_b32 v172, a172
  v_accvgpr_read_b32 v173, a173
  v_accvgpr_read_b32 v174, a174
  v_accvgpr_read_b32 v175, a175
  v_add_f32 v10, v10, v11
  v_add_f32 v12, v12, v13
  s_nop 1
  v_permlane32_swap_b32 v10, v12
  v_add_f32 v64, v10, v12
  v_mov_b32 v66, v64
  s_nop 1
  v_permlane32_swap_b32 v64, v66
  v_mul_f32 v64, 0xbb000000, v64
  v_mul_f32 v66, 0x3b000000, v66
  v_fma_f32 v66, -v64, v64, v66
  v_max_f32 v66, 0, v66
  v_add_f32 v66, 0x3727c5ac, v66
  v_rsq_f32 v66, v66
  s_nop 0
  v_mul_f32 v68, 0x3fb8aa3b, v66
  v_pk_fma_f32 v[48:49], v[160:161], v[64:65], v[48:49] op_sel_hi:[1,0,1]
  v_pk_fma_f32 v[50:51], v[162:163], v[64:65], v[50:51] op_sel_hi:[1,0,1]
  v_pk_fma_f32 v[52:53], v[164:165], v[64:65], v[52:53] op_sel_hi:[1,0,1]
  v_pk_fma_f32 v[54:55], v[166:167], v[64:65], v[54:55] op_sel_hi:[1,0,1]
  v_pk_fma_f32 v[56:57], v[168:169], v[64:65], v[56:57] op_sel_hi:[1,0,1]
  v_pk_fma_f32 v[58:59], v[170:171], v[64:65], v[58:59] op_sel_hi:[1,0,1]
  v_pk_fma_f32 v[60:61], v[172:173], v[64:65], v[60:61] op_sel_hi:[1,0,1]
  v_pk_fma_f32 v[62:63], v[174:175], v[64:65], v[62:63] op_sel_hi:[1,0,1]
  v_pk_fma_f32 v[32:33], v[144:145], v[64:65], v[32:33] op_sel_hi:[1,0,1]
  v_pk_fma_f32 v[34:35], v[146:147], v[64:65], v[34:35] op_sel_hi:[1,0,1]
  v_pk_fma_f32 v[36:37], v[148:149], v[64:65], v[36:37] op_sel_hi:[1,0,1]
  v_pk_fma_f32 v[38:39], v[150:151], v[64:65], v[38:39] op_sel_hi:[1,0,1]
  v_pk_fma_f32 v[40:41], v[152:153], v[64:65], v[40:41] op_sel_hi:[1,0,1]
  v_pk_fma_f32 v[42:43], v[154:155], v[64:65], v[42:43] op_sel_hi:[1,0,1]
  v_pk_fma_f32 v[44:45], v[156:157], v[64:65], v[44:45] op_sel_hi:[1,0,1]
  v_pk_fma_f32 v[46:47], v[158:159], v[64:65], v[46:47] op_sel_hi:[1,0,1]
  v_pk_fma_f32 v[16:17], v[128:129], v[64:65], v[16:17] op_sel_hi:[1,0,1]
  v_pk_fma_f32 v[18:19], v[130:131], v[64:65], v[18:19] op_sel_hi:[1,0,1]
  v_pk_fma_f32 v[20:21], v[132:133], v[64:65], v[20:21] op_sel_hi:[1,0,1]
  v_pk_fma_f32 v[22:23], v[134:135], v[64:65], v[22:23] op_sel_hi:[1,0,1]
  v_pk_fma_f32 v[24:25], v[136:137], v[64:65], v[24:25] op_sel_hi:[1,0,1]
  v_pk_fma_f32 v[26:27], v[138:139], v[64:65], v[26:27] op_sel_hi:[1,0,1]
  v_pk_fma_f32 v[28:29], v[140:141], v[64:65], v[28:29] op_sel_hi:[1,0,1]
  v_pk_fma_f32 v[30:31], v[142:143], v[64:65], v[30:31] op_sel_hi:[1,0,1]
  v_pk_mul_f32 v[48:49], v[48:49], v[66:67] op_sel_hi:[1,0]
  v_pk_mul_f32 v[50:51], v[50:51], v[66:67] op_sel_hi:[1,0]
  v_pk_mul_f32 v[52:53], v[52:53], v[66:67] op_sel_hi:[1,0]
  v_pk_mul_f32 v[54:55], v[54:55], v[66:67] op_sel_hi:[1,0]
  v_pk_mul_f32 v[56:57], v[56:57], v[66:67] op_sel_hi:[1,0]
  v_pk_mul_f32 v[58:59], v[58:59], v[66:67] op_sel_hi:[1,0]
  v_pk_mul_f32 v[60:61], v[60:61], v[66:67] op_sel_hi:[1,0]
  v_pk_mul_f32 v[62:63], v[62:63], v[66:67] op_sel_hi:[1,0]
  v_cvt_pk_bf16_f32 v128, v48, v49
  v_cvt_pk_bf16_f32 v129, v50, v51
  v_cvt_pk_bf16_f32 v130, v52, v53
  v_cvt_pk_bf16_f32 v131, v54, v55
  v_cvt_pk_bf16_f32 v132, v56, v57
  v_cvt_pk_bf16_f32 v133, v58, v59
  v_cvt_pk_bf16_f32 v134, v60, v61
  v_cvt_pk_bf16_f32 v135, v62, v63
  v_mfma_f32_32x32x16_bf16 v[176:191], v[128:131], v[112:115], 0
  s_nop 0
  v_mfma_f32_32x32x16_bf16 v[176:191], v[132:135], v[116:119], v[176:191]
  v_max3_f32 v70, v32, v33, v34
  v_max3_f32 v71, -v32, -v33, -v34
  v_max3_f32 v70, v70, v35, v36
  v_max3_f32 v71, v71, -v35, -v36
  v_max3_f32 v70, v70, v37, v38
  v_max3_f32 v71, v71, -v37, -v38
  v_max_f32 v70, v70, v39
  v_max_f32_e64 v71, v71, -v39
  s_nop 1
  v_permlane32_swap_b32 v70, v71
  v_max_f32 v72, v70, v71
  v_mov_b32 v74, v72
  s_nop 1
  v_permlane32_swap_b32 v72, v74
  v_mul_f32_e64 v72, -v72, v68
  v_mul_f32_e64 v74, -v74, v68
  v_pk_fma_f32 v[76:77], v[32:33], v[68:69], v[72:73] op_sel_hi:[1,0,0]
  v_pk_fma_f32 v[84:85], v[32:33], v[68:69], v[74:75] op_sel_hi:[1,0,0] neg_lo:[1,0,0] neg_hi:[1,0,0]
  v_pk_fma_f32 v[78:79], v[34:35], v[68:69], v[72:73] op_sel_hi:[1,0,0]
  v_pk_fma_f32 v[86:87], v[34:35], v[68:69], v[74:75] op_sel_hi:[1,0,0] neg_lo:[1,0,0] neg_hi:[1,0,0]
  v_pk_fma_f32 v[80:81], v[36:37], v[68:69], v[72:73] op_sel_hi:[1,0,0]
  v_pk_fma_f32 v[88:89], v[36:37], v[68:69], v[74:75] op_sel_hi:[1,0,0] neg_lo:[1,0,0] neg_hi:[1,0,0]
  v_pk_fma_f32 v[82:83], v[38:39], v[68:69], v[72:73] op_sel_hi:[1,0,0]
  v_pk_fma_f32 v[90:91], v[38:39], v[68:69], v[74:75] op_sel_hi:[1,0,0] neg_lo:[1,0,0] neg_hi:[1,0,0]
  v_exp_f32 v76, v76
  v_exp_f32 v77, v77
  v_exp_f32 v78, v78
  v_exp_f32 v79, v79
  v_exp_f32 v80, v80
  v_exp_f32 v81, v81
  v_exp_f32 v82, v82
  v_exp_f32 v83, v83
  v_exp_f32 v84, v84
  v_exp_f32 v85, v85
  v_exp_f32 v86, v86
  v_exp_f32 v87, v87
  v_exp_f32 v88, v88
  v_exp_f32 v89, v89
  v_exp_f32 v90, v90
  v_exp_f32 v91, v91
  v_pk_add_f32 v[92:93], v[76:77], v[78:79]
  v_pk_add_f32 v[94:95], v[84:85], v[86:87]
  v_pk_add_f32 v[92:93], v[92:93], v[80:81]
  v_pk_add_f32 v[94:95], v[94:95], v[88:89]
  v_pk_add_f32 v[92:93], v[92:93], v[82:83]
  v_pk_add_f32 v[94:95], v[94:95], v[90:91]
  v_add_f32 v70, v92, v93
  v_add_f32 v71, v94, v95
  s_nop 1
  v_permlane32_swap_b32 v70, v71
  v_add_f32 v72, v70, v71
  v_mov_b32 v74, v72
  s_nop 1
  v_permlane32_swap_b32 v72, v74
  v_rcp_f32 v72, v72
  v_rcp_f32 v74, v74
  v_pk_mul_f32 v[76:77], v[76:77], v[72:73] op_sel_hi:[1,0]
  v_pk_mul_f32 v[78:79], v[78:79], v[72:73] op_sel_hi:[1,0]
  v_pk_mul_f32 v[80:81], v[80:81], v[72:73] op_sel_hi:[1,0]
  v_pk_mul_f32 v[82:83], v[82:83], v[72:73] op_sel_hi:[1,0]
  v_pk_mul_f32 v[84:85], v[84:85], v[74:75] op_sel_hi:[1,0]
  v_pk_mul_f32 v[86:87], v[86:87], v[74:75] op_sel_hi:[1,0]
  v_pk_mul_f32 v[88:89], v[88:89], v[74:75] op_sel_hi:[1,0]
  v_pk_mul_f32 v[90:91], v[90:91], v[74:75] op_sel_hi:[1,0]
  v_cvt_pk_bf16_f32 v136, v76, v77
  v_cvt_pk_bf16_f32 v137, v78, v79
  v_cvt_pk_bf16_f32 v138, v80, v81
  v_cvt_pk_bf16_f32 v139, v82, v83
  v_cvt_pk_bf16_f32 v140, v84, v85
  v_cvt_pk_bf16_f32 v141, v86, v87
  v_cvt_pk_bf16_f32 v142, v88, v89
  v_cvt_pk_bf16_f32 v143, v90, v91
  v_mfma_f32_32x32x16_bf16 v[200:215], v[136:139], v[112:115], 0
  s_nop 0
  v_mfma_f32_32x32x16_bf16 v[200:215], v[140:143], v[116:119], v[200:215]
  v_cmp_gt_u32 vcc, 16, v3
  v_mov_b32 v96, 0x3f803f80
  v_cvt_pk_bf16_f32 v192, v176, v177
  v_cvt_pk_bf16_f32 v193, v178, v179
  v_cvt_pk_bf16_f32 v194, v180, v181
  v_cvt_pk_bf16_f32 v195, v182, v183
  v_cvt_pk_bf16_f32 v196, v184, v185
  v_cvt_pk_bf16_f32 v197, v186, v187
  v_cvt_pk_bf16_f32 v198, v188, v189
  v_cvt_pk_bf16_f32 v199, v190, v191
  v_cndmask_b32 v152, v96, v192, vcc
  v_cndmask_b32 v160, v192, v96, vcc
  v_cndmask_b32 v153, v96, v193, vcc
  v_cndmask_b32 v161, v193, v96, vcc
  v_cndmask_b32 v154, v96, v194, vcc
  v_cndmask_b32 v162, v194, v96, vcc
  v_cndmask_b32 v155, v96, v195, vcc
  v_cndmask_b32 v163, v195, v96, vcc
  v_cndmask_b32 v156, v96, v196, vcc
  v_cndmask_b32 v164, v196, v96, vcc
  v_cndmask_b32 v157, v96, v197, vcc
  v_cndmask_b32 v165, v197, v96, vcc
  v_cndmask_b32 v158, v96, v198, vcc
  v_cndmask_b32 v166, v198, v96, vcc
  v_cndmask_b32 v159, v96, v199, vcc
  v_cndmask_b32 v167, v199, v96, vcc
  v_max3_f32 v70, v40, v41, v42
  v_max3_f32 v71, -v40, -v41, -v42
  v_max3_f32 v70, v70, v43, v44
  v_max3_f32 v71, v71, -v43, -v44
  v_max3_f32 v70, v70, v45, v46
  v_max3_f32 v71, v71, -v45, -v46
  v_max_f32 v70, v70, v47
  v_max_f32_e64 v71, v71, -v47
  s_nop 1
  v_permlane32_swap_b32 v70, v71
  v_max_f32 v72, v70, v71
  v_mov_b32 v74, v72
  s_nop 1
  v_permlane32_swap_b32 v72, v74
  v_mul_f32_e64 v72, -v72, v68
  v_mul_f32_e64 v74, -v74, v68
  v_pk_fma_f32 v[76:77], v[40:41], v[68:69], v[72:73] op_sel_hi:[1,0,0]
  v_pk_fma_f32 v[84:85], v[40:41], v[68:69], v[74:75] op_sel_hi:[1,0,0] neg_lo:[1,0,0] neg_hi:[1,0,0]
  v_pk_fma_f32 v[78:79], v[42:43], v[68:69], v[72:73] op_sel_hi:[1,0,0]
  v_pk_fma_f32 v[86:87], v[42:43], v[68:69], v[74:75] op_sel_hi:[1,0,0] neg_lo:[1,0,0] neg_hi:[1,0,0]
  v_pk_fma_f32 v[80:81], v[44:45], v[68:69], v[72:73] op_sel_hi:[1,0,0]
  v_pk_fma_f32 v[88:89], v[44:45], v[68:69], v[74:75] op_sel_hi:[1,0,0] neg_lo:[1,0,0] neg_hi:[1,0,0]
  v_pk_fma_f32 v[82:83], v[46:47], v[68:69], v[72:73] op_sel_hi:[1,0,0]
  v_pk_fma_f32 v[90:91], v[46:47], v[68:69], v[74:75] op_sel_hi:[1,0,0] neg_lo:[1,0,0] neg_hi:[1,0,0]
  v_exp_f32 v76, v76
  v_exp_f32 v77, v77
  v_exp_f32 v78, v78
  v_exp_f32 v79, v79
  v_exp_f32 v80, v80
  v_exp_f32 v81, v81
  v_exp_f32 v82, v82
  v_exp_f32 v83, v83
  v_exp_f32 v84, v84
  v_exp_f32 v85, v85
  v_exp_f32 v86, v86
  v_exp_f32 v87, v87
  v_exp_f32 v88, v88
  v_exp_f32 v89, v89
  v_exp_f32 v90, v90
  v_exp_f32 v91, v91
  v_pk_add_f32 v[92:93], v[76:77], v[78:79]
  v_pk_add_f32 v[94:95], v[84:85], v[86:87]
  v_pk_add_f32 v[92:93], v[92:93], v[80:81]
  v_pk_add_f32 v[94:95], v[94:95], v[88:89]
  v_pk_add_f32 v[92:93], v[92:93], v[82:83]
  v_pk_add_f32 v[94:95], v[94:95], v[90:91]
  v_add_f32 v70, v92, v93
  v_add_f32 v71, v94, v95
  s_nop 1
  v_permlane32_swap_b32 v70, v71
  v_add_f32 v72, v70, v71
  v_mov_b32 v74, v72
  s_nop 1
  v_permlane32_swap_b32 v72, v74
  v_rcp_f32 v72, v72
  v_rcp_f32 v74, v74
  v_pk_mul_f32 v[76:77], v[76:77], v[72:73] op_sel_hi:[1,0]
  v_pk_mul_f32 v[78:79], v[78:79], v[72:73] op_sel_hi:[1,0]
  v_pk_mul_f32 v[80:81], v[80:81], v[72:73] op_sel_hi:[1,0]
  v_pk_mul_f32 v[82:83], v[82:83], v[72:73] op_sel_hi:[1,0]
  v_pk_mul_f32 v[84:85], v[84:85], v[74:75] op_sel_hi:[1,0]
  v_pk_mul_f32 v[86:87], v[86:87], v[74:75] op_sel_hi:[1,0]
  v_pk_mul_f32 v[88:89], v[88:89], v[74:75] op_sel_hi:[1,0]
  v_pk_mul_f32 v[90:91], v[90:91], v[74:75] op_sel_hi:[1,0]
  v_cvt_pk_bf16_f32 v144, v76, v77
  v_cvt_pk_bf16_f32 v145, v78, v79
  v_cvt_pk_bf16_f32 v146, v80, v81
  v_cvt_pk_bf16_f32 v147, v82, v83
  v_cvt_pk_bf16_f32 v148, v84, v85
  v_cvt_pk_bf16_f32 v149, v86, v87
  v_cvt_pk_bf16_f32 v150, v88, v89
  v_cvt_pk_bf16_f32 v151, v90, v91
  v_mfma_f32_32x32x16_bf16 v[216:231], v[144:147], v[112:115], 0
  s_nop 0
  v_mfma_f32_32x32x16_bf16 v[216:231], v[148:151], v[116:119], v[216:231]
  s_lshl_b32 s50, s41, 18
  s_lshl_b32 s51, s43, 11
  s_add_u32 s50, s50, s51
  s_add_u32 s50, s50, 22020096
  s_add_u32 s51, s50, 131072
  v_max3_f32 v70, v16, v17, v18
  v_max3_f32 v71, -v16, -v17, -v18
  v_max3_f32 v70, v70, v19, v20
  v_max3_f32 v71, v71, -v19, -v20
  v_max3_f32 v70, v70, v21, v22
  v_max3_f32 v71, v71, -v21, -v22
  v_max_f32 v70, v70, v23
  v_max_f32_e64 v71, v71, -v23
  s_nop 1
  v_permlane32_swap_b32 v70, v71
  v_max_f32 v72, v70, v71
  v_mov_b32 v74, v72
  s_nop 1
  v_permlane32_swap_b32 v72, v74
  v_mul_f32_e64 v72, -v72, v68
  v_mul_f32_e64 v74, -v74, v68
  v_pk_fma_f32 v[76:77], v[16:17], v[68:69], v[72:73] op_sel_hi:[1,0,0]
  v_pk_fma_f32 v[84:85], v[16:17], v[68:69], v[74:75] op_sel_hi:[1,0,0] neg_lo:[1,0,0] neg_hi:[1,0,0]
  v_pk_fma_f32 v[78:79], v[18:19], v[68:69], v[72:73] op_sel_hi:[1,0,0]
  v_pk_fma_f32 v[86:87], v[18:19], v[68:69], v[74:75] op_sel_hi:[1,0,0] neg_lo:[1,0,0] neg_hi:[1,0,0]
  v_pk_fma_f32 v[80:81], v[20:21], v[68:69], v[72:73] op_sel_hi:[1,0,0]
  v_pk_fma_f32 v[88:89], v[20:21], v[68:69], v[74:75] op_sel_hi:[1,0,0] neg_lo:[1,0,0] neg_hi:[1,0,0]
  v_pk_fma_f32 v[82:83], v[22:23], v[68:69], v[72:73] op_sel_hi:[1,0,0]
  v_pk_fma_f32 v[90:91], v[22:23], v[68:69], v[74:75] op_sel_hi:[1,0,0] neg_lo:[1,0,0] neg_hi:[1,0,0]
  v_exp_f32 v76, v76
  v_exp_f32 v77, v77
  v_exp_f32 v78, v78
  v_exp_f32 v79, v79
  v_exp_f32 v80, v80
  v_exp_f32 v81, v81
  v_exp_f32 v82, v82
  v_exp_f32 v83, v83
  v_exp_f32 v84, v84
  v_exp_f32 v85, v85
  v_exp_f32 v86, v86
  v_exp_f32 v87, v87
  v_exp_f32 v88, v88
  v_exp_f32 v89, v89
  v_exp_f32 v90, v90
  v_exp_f32 v91, v91
  v_pk_add_f32 v[92:93], v[76:77], v[78:79]
  v_pk_add_f32 v[94:95], v[84:85], v[86:87]
  v_pk_add_f32 v[92:93], v[92:93], v[80:81]
  v_pk_add_f32 v[94:95], v[94:95], v[88:89]
  v_pk_add_f32 v[92:93], v[92:93], v[82:83]
  v_pk_add_f32 v[94:95], v[94:95], v[90:91]
  v_add_f32 v70, v92, v93
  v_add_f32 v71, v94, v95
  s_nop 1
  v_permlane32_swap_b32 v70, v71
  v_add_f32 v72, v70, v71
  v_mov_b32 v74, v72
  s_nop 1
  v_permlane32_swap_b32 v72, v74
  v_rcp_f32 v72, v72
  v_rcp_f32 v74, v74
  v_pk_mul_f32 v[76:77], v[76:77], v[72:73] op_sel_hi:[1,0]
  v_pk_mul_f32 v[78:79], v[78:79], v[72:73] op_sel_hi:[1,0]
  v_pk_mul_f32 v[80:81], v[80:81], v[72:73] op_sel_hi:[1,0]
  v_pk_mul_f32 v[82:83], v[82:83], v[72:73] op_sel_hi:[1,0]
  v_pk_mul_f32 v[84:85], v[84:85], v[74:75] op_sel_hi:[1,0]
  v_pk_mul_f32 v[86:87], v[86:87], v[74:75] op_sel_hi:[1,0]
  v_pk_mul_f32 v[88:89], v[88:89], v[74:75] op_sel_hi:[1,0]
  v_pk_mul_f32 v[90:91], v[90:91], v[74:75] op_sel_hi:[1,0]
  v_cvt_pk_bf16_f32 v100, v76, v77
  v_cvt_pk_bf16_f32 v101, v78, v79
  v_cvt_pk_bf16_f32 v102, v80, v81
  v_cvt_pk_bf16_f32 v103, v82, v83
  v_cvt_pk_bf16_f32 v104, v84, v85
  v_cvt_pk_bf16_f32 v105, v86, v87
  v_cvt_pk_bf16_f32 v106, v88, v89
  v_cvt_pk_bf16_f32 v107, v90, v91
  buffer_store_dwordx4 v[100:103], v5, s[20:23], s50 offen sc0 sc1
  buffer_store_dwordx4 v[104:107], v5, s[20:23], s50 offen offset:1024 sc0 sc1
  v_cvt_pk_bf16_f32 v168, v200, v201
  v_cvt_pk_bf16_f32 v169, v202, v203
  v_cvt_pk_bf16_f32 v170, v204, v205
  v_cvt_pk_bf16_f32 v171, v206, v207
  v_cvt_pk_bf16_f32 v172, v208, v209
  v_cvt_pk_bf16_f32 v173, v210, v211
  v_cvt_pk_bf16_f32 v174, v212, v213
  v_cvt_pk_bf16_f32 v175, v214, v215
  v_mfma_f32_32x32x16_bf16 v[176:191], v[168:171], v[152:155], 0
  s_nop 0
  v_mfma_f32_32x32x16_bf16 v[176:191], v[172:175], v[156:159], v[176:191]
  v_cvt_pk_bf16_f32 v232, v216, v217
  v_cvt_pk_bf16_f32 v233, v218, v219
  v_cvt_pk_bf16_f32 v234, v220, v221
  v_cvt_pk_bf16_f32 v235, v222, v223
  v_cvt_pk_bf16_f32 v236, v224, v225
  v_cvt_pk_bf16_f32 v237, v226, v227
  v_cvt_pk_bf16_f32 v238, v228, v229
  v_cvt_pk_bf16_f32 v239, v230, v231
  v_mfma_f32_32x32x16_bf16 v[32:47], v[232:235], v[160:163], 0
  s_nop 0
  v_mfma_f32_32x32x16_bf16 v[32:47], v[236:239], v[164:167], v[32:47]
  v_mul_u32_u24 v96, 272, v4
  s_mul_i32 s50, s3, 4352
  s_add_u32 s50, s50, 98304
  v_add_u32 v96, s50, v96
  v_min_u32 v97, 16, v3
  v_lshl_add_u32 v97, v97, 4, v96
  v_xor_b32 v98, 16, v3
  v_min_u32 v98, 16, v98
  v_lshl_add_u32 v98, v98, 4, v96
  ds_write_b128 v97, v[176:179] offset:0
  ds_write_b128 v97, v[180:183] offset:544
  ds_write_b128 v97, v[184:187] offset:1088
  ds_write_b128 v97, v[188:191] offset:1632
  ds_write_b128 v98, v[32:35] offset:2176
  ds_write_b128 v98, v[36:39] offset:2720
  ds_write_b128 v98, v[40:43] offset:3264
  ds_write_b128 v98, v[44:47] offset:3808
  v_lshlrev_b32 v96, 2, v0
  v_add_u32 v97, 98304, v96
  s_mul_i32 s50, s41, 4352
  s_add_u32 s50, s50, 21041152
  s_waitcnt lgkmcnt(0)
  s_barrier
  ds_read_b32 v100, v97 offset:0
  ds_read_b32 v101, v97 offset:4352
  ds_read_b32 v102, v97 offset:8704
  ds_read_b32 v103, v97 offset:13056
  ds_read_b32 v104, v97 offset:1024
  ds_read_b32 v105, v97 offset:5376
  ds_read_b32 v106, v97 offset:9728
  ds_read_b32 v107, v97 offset:14080
  ds_read_b32 v108, v97 offset:2048
  ds_read_b32 v109, v97 offset:6400
  ds_read_b32 v110, v97 offset:10752
  ds_read_b32 v111, v97 offset:15104
  s_waitcnt lgkmcnt(0)
  ds_read_b32 v112, v97 offset:3072
  ds_read_b32 v113, v97 offset:7424
  ds_read_b32 v114, v97 offset:11776
  ds_read_b32 v115, v97 offset:16128
  ds_read_b32 v116, v97 offset:4096
  ds_read_b32 v117, v97 offset:8448
  ds_read_b32 v118, v97 offset:12800
  ds_read_b32 v119, v97 offset:17152
  s_waitcnt lgkmcnt(0)
  v_add_f32 v100, v100, v101
  v_add_f32 v102, v102, v103
  v_add_f32 v100, v100, v102
  v_add_f32 v104, v104, v105
  v_add_f32 v106, v106, v107
  v_add_f32 v104, v104, v106
  v_add_f32 v108, v108, v109
  v_add_f32 v110, v110, v111
  v_add_f32 v108, v108, v110
  v_add_f32 v112, v112, v113
  v_add_f32 v114, v114, v115
  v_add_f32 v112, v112, v114
  v_add_f32 v116, v116, v117
  v_add_f32 v118, v118, v119
  v_add_f32 v116, v116, v118
  buffer_atomic_add_f32 v100, v96, s[20:23], s50 offen offset:0 sc1
  buffer_atomic_add_f32 v104, v96, s[20:23], s50 offen offset:1024 sc1
  buffer_atomic_add_f32 v108, v96, s[20:23], s50 offen offset:2048 sc1
  buffer_atomic_add_f32 v112, v96, s[20:23], s50 offen offset:3072 sc1
  s_cmp_lg_u32 s3, 0
  s_cbranch_scc1 K21_na
  s_add_u32 s50, s50, 4096
  buffer_atomic_add_f32 v116, v96, s[20:23], s50 offen sc1
K21_na:
  v_max3_f32 v70, v24, v25, v26
  v_max3_f32 v71, -v24, -v25, -v26
  v_max3_f32 v70, v70, v27, v28
  v_max3_f32 v71, v71, -v27, -v28
  v_max3_f32 v70, v70, v29, v30
  v_max3_f32 v71, v71, -v29, -v30
  v_max_f32 v70, v70, v31
  v_max_f32_e64 v71, v71, -v31
  s_nop 1
  v_permlane32_swap_b32 v70, v71
  v_max_f32 v72, v70, v71
  v_mov_b32 v74, v72
  s_nop 1
  v_permlane32_swap_b32 v72, v74
  v_mul_f32_e64 v72, -v72, v68
  v_mul_f32_e64 v74, -v74, v68
  v_pk_fma_f32 v[76:77], v[24:25], v[68:69], v[72:73] op_sel_hi:[1,0,0]
  v_pk_fma_f32 v[84:85], v[24:25], v[68:69], v[74:75] op_sel_hi:[1,0,0] neg_lo:[1,0,0] neg_hi:[1,0,0]
  v_pk_fma_f32 v[78:79], v[26:27], v[68:69], v[72:73] op_sel_hi:[1,0,0]
  v_pk_fma_f32 v[86:87], v[26:27], v[68:69], v[74:75] op_sel_hi:[1,0,0] neg_lo:[1,0,0] neg_hi:[1,0,0]
  v_pk_fma_f32 v[80:81], v[28:29], v[68:69], v[72:73] op_sel_hi:[1,0,0]
  v_pk_fma_f32 v[88:89], v[28:29], v[68:69], v[74:75] op_sel_hi:[1,0,0] neg_lo:[1,0,0] neg_hi:[1,0,0]
  v_pk_fma_f32 v[82:83], v[30:31], v[68:69], v[72:73] op_sel_hi:[1,0,0]
  v_pk_fma_f32 v[90:91], v[30:31], v[68:69], v[74:75] op_sel_hi:[1,0,0] neg_lo:[1,0,0] neg_hi:[1,0,0]
  v_exp_f32 v76, v76
  v_exp_f32 v77, v77
  v_exp_f32 v78, v78
  v_exp_f32 v79, v79
  v_exp_f32 v80, v80
  v_exp_f32 v81, v81
  v_exp_f32 v82, v82
  v_exp_f32 v83, v83
  v_exp_f32 v84, v84
  v_exp_f32 v85, v85
  v_exp_f32 v86, v86
  v_exp_f32 v87, v87
  v_exp_f32 v88, v88
  v_exp_f32 v89, v89
  v_exp_f32 v90, v90
  v_exp_f32 v91, v91
  v_pk_add_f32 v[92:93], v[76:77], v[78:79]
  v_pk_add_f32 v[94:95], v[84:85], v[86:87]
  v_pk_add_f32 v[92:93], v[92:93], v[80:81]
  v_pk_add_f32 v[94:95], v[94:95], v[88:89]
  v_pk_add_f32 v[92:93], v[92:93], v[82:83]
  v_pk_add_f32 v[94:95], v[94:95], v[90:91]
  v_add_f32 v70, v92, v93
  v_add_f32 v71, v94, v95
  s_nop 1
  v_permlane32_swap_b32 v70, v71
  v_add_f32 v72, v70, v71
  v_mov_b32 v74, v72
  s_nop 1
  v_permlane32_swap_b32 v72, v74
  v_rcp_f32 v72, v72
  v_rcp_f32 v74, v74
  v_pk_mul_f32 v[76:77], v[76:77], v[72:73] op_sel_hi:[1,0]
  v_pk_mul_f32 v[78:79], v[78:79], v[72:73] op_sel_hi:[1,0]
  v_pk_mul_f32 v[80:81], v[80:81], v[72:73] op_sel_hi:[1,0]
  v_pk_mul_f32 v[82:83], v[82:83], v[72:73] op_sel_hi:[1,0]
  v_pk_mul_f32 v[84:85], v[84:85], v[74:75] op_sel_hi:[1,0]
  v_pk_mul_f32 v[86:87], v[86:87], v[74:75] op_sel_hi:[1,0]
  v_pk_mul_f32 v[88:89], v[88:89], v[74:75] op_sel_hi:[1,0]
  v_pk_mul_f32 v[90:91], v[90:91], v[74:75] op_sel_hi:[1,0]
  v_cvt_pk_bf16_f32 v128, v76, v77
  v_cvt_pk_bf16_f32 v129, v78, v79
  v_cvt_pk_bf16_f32 v130, v80, v81
  v_cvt_pk_bf16_f32 v131, v82, v83
  v_cvt_pk_bf16_f32 v132, v84, v85
  v_cvt_pk_bf16_f32 v133, v86, v87
  v_cvt_pk_bf16_f32 v134, v88, v89
  v_cvt_pk_bf16_f32 v135, v90, v91
  buffer_store_dwordx4 v[128:131], v5, s[20:23], s51 offen sc0 sc1
  buffer_store_dwordx4 v[132:135], v5, s[20:23], s51 offen offset:1024 sc0 sc1
K21_end:
  s_waitcnt vmcnt(0) lgkmcnt(0)
  s_barrier
  s_cmp_lg_u32 s3, 0
  s_cbranch_scc1 BAR2_w
  v_mov_b32 v1, 1
  v_lshlrev_b32 v2, 6, v0
  v_lshlrev_b32 v3, 10, v0
  s_lshl_b32 s40, s40, 10
  s_lshl_b32 s41, s41, 6
  s_add_u32 s40, s40, s41
  s_add_u32 s40, s40, 21209088
  s_and_b32 s43, s2, 7
  s_lshl_b32 s43, s43, 1
  s_lshr_b32 s42, s2, 7
  s_add_u32 s43, s43, s42
  s_lshl_b32 s41, s43, 10
  s_add_u32 s41, s41, 21209088
  s_mov_b64 exec, 1
  buffer_store_dword v1, v2, s[20:23], s40 offen sc0 sc1
  s_mov_b64 exec, 0xffff
  s_mov_b32 s42, 0
BAR2_p:
  buffer_load_dword v4, v2, s[20:23], s41 offen sc0 sc1
  s_add_u32 s42, s42, 1
  s_waitcnt vmcnt(0)
  v_cmp_ne_u32 vcc, 1, v4
  s_cbranch_vccz BAR2_pd
  s_cmp_lt_u32 s42, 0x20000
  s_cbranch_scc1 BAR2_p
BAR2_pd:
  s_bfe_u32 s42, s2, 0x40003
  s_cmp_lg_u32 s42, 0
  s_cbranch_scc1 BAR2_n
  s_lshl_b32 s40, s43, 6
  s_add_u32 s40, s40, 21229568
  s_mov_b64 exec, 15
  buffer_store_dword v1, v3, s[20:23], s40 offen sc0 sc1
BAR2_n:
  s_mov_b64 exec, -1
BAR2_w:

  s_barrier
  s_and_b32 s40, s2, 7
  s_lshl_b32 s40, s40, 3
  s_lshr_b32 s41, s2, 5
  s_add_u32 s40, s40, s41
  s_bfe_u32 s41, s2, 0x20003
  v_lshrrev_b32 v1, 6, v0
  v_and_b32 v2, 63, v0
  v_and_b32 v3, 31, v0
  v_readfirstlane_b32 s3, v1
  v_bfe_u32 v4, v0, 5, 1
  v_lshlrev_b32 v5, 4, v2
  v_min_u32 v6, 16, v3
  v_lshlrev_b32 v6, 4, v6
  v_mul_u32_u24 v7, 272, v4
  v_add_u32 v6, v6, v7
  s_mul_i32 s42, s3, 17408
  s_add_u32 s42, s42, 21041152
  s_lshl_b32 s43, s3, 20
  s_lshl_b32 s44, s40, 11
  s_add_u32 s43, s43, s44
  s_add_u32 s43, s43, 22020096
  s_lshl_b32 s44, s41, 2
  s_add_u32 s44, s44, s3
  s_lshl_b32 s45, s44, 15
  s_add_u32 s45, s45, 7340032
  s_waitcnt lgkmcnt(0)
  s_mov_b32 s20, s18
  s_and_b32 s21, s19, 0xffff
  s_mov_b32 s22, 26214400
  s_mov_b32 s23, 0x20000
  buffer_load_dwordx4 v[192:195], v5, s[20:23], s43 offen offset:0
  buffer_load_dwordx4 v[196:199], v5, s[20:23], s43 offen offset:1024
  s_add_u32 s43, s43, 131072
  buffer_load_dwordx4 v[200:203], v5, s[20:23], s43 offen offset:0
  buffer_load_dwordx4 v[204:207], v5, s[20:23], s43 offen offset:1024
  s_add_u32 s43, s43, 131072
  buffer_load_dwordx4 v[208:211], v5, s[20:23], s43 offen offset:0
  buffer_load_dwordx4 v[212:215], v5, s[20:23], s43 offen offset:1024
  s_add_u32 s43, s43, 131072
  buffer_load_dwordx4 v[216:219], v5, s[20:23], s43 offen offset:0
  buffer_load_dwordx4 v[220:223], v5, s[20:23], s43 offen offset:1024
  s_add_u32 s43, s43, 131072
  buffer_load_dwordx4 v[224:227], v5, s[20:23], s43 offen offset:0
  buffer_load_dwordx4 v[228:231], v5, s[20:23], s43 offen offset:1024
  s_add_u32 s43, s43, 131072
  buffer_load_dwordx4 v[232:235], v5, s[20:23], s43 offen offset:0
  buffer_load_dwordx4 v[236:239], v5, s[20:23], s43 offen offset:1024
  s_add_u32 s43, s43, 131072
  buffer_load_dwordx4 v[240:243], v5, s[20:23], s43 offen offset:0
  buffer_load_dwordx4 v[244:247], v5, s[20:23], s43 offen offset:1024
  s_add_u32 s43, s43, 131072
  buffer_load_dwordx4 v[248:251], v5, s[20:23], s43 offen offset:0
  buffer_load_dwordx4 v[252:255], v5, s[20:23], s43 offen offset:1024
  s_lshl_b32 s46, s44, 17
  s_lshl_b32 s47, s40, 9
  s_add_u32 s46, s46, s47
  s_add_u32 s47, s46, 14680064
  s_add_u32 s49, s46, 8388608
  s_add_u32 s46, s46, 14680064
  v_lshlrev_b32 v8, 4, v3
  v_lshl_add_u32 v9, v4, 3, v8
  v_lshl_add_u32 v8, v4, 15, v8
  s_lshl_b32 s48, s3, 13
  v_add_u32 v11, 98304, v5
  v_add_u32 v10, s48, v11
  buffer_load_dwordx2 v[48:49], v9, s[20:23], s47 offen
  s_add_u32 s47, s47, 32768
  buffer_load_dwordx2 v[50:51], v9, s[20:23], s47 offen
  s_add_u32 s47, s47, 32768
  buffer_load_dwordx2 v[52:53], v9, s[20:23], s47 offen
  s_add_u32 s47, s47, 32768
  buffer_load_dwordx2 v[54:55], v9, s[20:23], s47 offen
  s_add_u32 s47, s47, 32768
  s_cmp_lg_u32 s3, 0
  s_cbranch_scc1 BAR2_x
  v_lshlrev_b32 v14, 6, v0
  s_bfe_u32 s55, s2, 0x20003
  s_lshl_b32 s55, s55, 10
  s_add_u32 s55, s55, 21229568
  s_mov_b64 exec, 0xffff
  s_mov_b32 s51, 0
BAR2_q:
  buffer_load_dword v15, v14, s[20:23], s55 offen sc0 sc1
  s_add_u32 s51, s51, 1
  s_waitcnt vmcnt(0)
  v_cmp_ne_u32 vcc, 1, v15
  s_cbranch_vccz BAR2_qd
  s_cmp_lt_u32 s51, 0x20000
  s_cbranch_scc1 BAR2_q
BAR2_qd:
  s_mov_b64 exec, -1
BAR2_x:
  s_barrier
  buffer_load_dwordx4 v[64:67], v6, s[20:23], s42 offen offset:0
  buffer_load_dwordx4 v[68:71], v6, s[20:23], s42 offen offset:544
  buffer_load_dwordx4 v[72:75], v6, s[20:23], s42 offen offset:1088
  buffer_load_dwordx4 v[76:79], v6, s[20:23], s42 offen offset:1632
  s_add_u32 s42, s42, 2176
  buffer_load_dwordx4 v[80:83], v6, s[20:23], s42 offen offset:0
  buffer_load_dwordx4 v[84:87], v6, s[20:23], s42 offen offset:544
  buffer_load_dwordx4 v[88:91], v6, s[20:23], s42 offen offset:1088
  buffer_load_dwordx4 v[92:95], v6, s[20:23], s42 offen offset:1632
  s_add_u32 s42, s42, 2176
  buffer_load_dwordx4 v[96:99], v6, s[20:23], s42 offen offset:0
  buffer_load_dwordx4 v[100:103], v6, s[20:23], s42 offen offset:544
  buffer_load_dwordx4 v[104:107], v6, s[20:23], s42 offen offset:1088
  buffer_load_dwordx4 v[108:111], v6, s[20:23], s42 offen offset:1632
  s_add_u32 s42, s42, 2176
  buffer_load_dwordx4 v[112:115], v6, s[20:23], s42 offen offset:0
  buffer_load_dwordx4 v[116:119], v6, s[20:23], s42 offen offset:544
  buffer_load_dwordx4 v[120:123], v6, s[20:23], s42 offen offset:1088
  buffer_load_dwordx4 v[124:127], v6, s[20:23], s42 offen offset:1632
  s_add_u32 s42, s42, 2176
  s_waitcnt vmcnt(12)
  v_cvt_pk_bf16_f32 v64, v64, v65
  v_cvt_pk_bf16_f32 v65, v66, v67
  v_cvt_pk_bf16_f32 v66, v68, v69
  v_cvt_pk_bf16_f32 v67, v70, v71
  v_cvt_pk_bf16_f32 v68, v72, v73
  v_cvt_pk_bf16_f32 v69, v74, v75
  v_cvt_pk_bf16_f32 v70, v76, v77
  v_cvt_pk_bf16_f32 v71, v78, v79
  v_mfma_f32_32x32x16_bf16 v[16:31], v[64:67], v[192:195], 0
  s_nop 0
  v_mfma_f32_32x32x16_bf16 v[16:31], v[68:71], v[196:199], v[16:31]
  buffer_load_dwordx4 v[128:131], v6, s[20:23], s42 offen offset:0
  buffer_load_dwordx4 v[132:135], v6, s[20:23], s42 offen offset:544
  buffer_load_dwordx4 v[136:139], v6, s[20:23], s42 offen offset:1088
  buffer_load_dwordx4 v[140:143], v6, s[20:23], s42 offen offset:1632
  s_add_u32 s42, s42, 2176
  s_waitcnt vmcnt(12)
  v_cvt_pk_bf16_f32 v80, v80, v81
  v_cvt_pk_bf16_f32 v81, v82, v83
  v_cvt_pk_bf16_f32 v82, v84, v85
  v_cvt_pk_bf16_f32 v83, v86, v87
  v_cvt_pk_bf16_f32 v84, v88, v89
  v_cvt_pk_bf16_f32 v85, v90, v91
  v_cvt_pk_bf16_f32 v86, v92, v93
  v_cvt_pk_bf16_f32 v87, v94, v95
  v_mfma_f32_32x32x16_bf16 v[32:47], v[80:83], v[200:203], 0
  s_nop 0
  v_mfma_f32_32x32x16_bf16 v[32:47], v[84:87], v[204:207], v[32:47]
  buffer_load_dwordx4 v[144:147], v6, s[20:23], s42 offen offset:0
  buffer_load_dwordx4 v[148:151], v6, s[20:23], s42 offen offset:544
  buffer_load_dwordx4 v[152:155], v6, s[20:23], s42 offen offset:1088
  buffer_load_dwordx4 v[156:159], v6, s[20:23], s42 offen offset:1632
  s_add_u32 s42, s42, 2176
  v_add_f32 v12, 0x358637bd, v24
  v_rcp_f32 v12, v12
  s_nop 0
  v_pk_mul_f32 v[16:17], v[16:17], v[12:13] op_sel_hi:[1,0]
  v_pk_mul_f32 v[18:19], v[18:19], v[12:13] op_sel_hi:[1,0]
  v_pk_mul_f32 v[20:21], v[20:21], v[12:13] op_sel_hi:[1,0]
  v_pk_mul_f32 v[22:23], v[22:23], v[12:13] op_sel_hi:[1,0]
  v_cvt_pk_bf16_f32 v56, v16, v17
  v_cvt_pk_bf16_f32 v57, v18, v19
  v_cvt_pk_bf16_f32 v58, v20, v21
  v_cvt_pk_bf16_f32 v59, v22, v23
  ds_write_b128 v10, v[56:59] offset:0
  s_waitcnt vmcnt(12)
  v_cvt_pk_bf16_f32 v96, v96, v97
  v_cvt_pk_bf16_f32 v97, v98, v99
  v_cvt_pk_bf16_f32 v98, v100, v101
  v_cvt_pk_bf16_f32 v99, v102, v103
  v_cvt_pk_bf16_f32 v100, v104, v105
  v_cvt_pk_bf16_f32 v101, v106, v107
  v_cvt_pk_bf16_f32 v102, v108, v109
  v_cvt_pk_bf16_f32 v103, v110, v111
  v_mfma_f32_32x32x16_bf16 v[16:31], v[96:99], v[208:211], 0
  s_nop 0
  v_mfma_f32_32x32x16_bf16 v[16:31], v[100:103], v[212:215], v[16:31]
  buffer_load_dwordx4 v[160:163], v6, s[20:23], s42 offen offset:0
  buffer_load_dwordx4 v[164:167], v6, s[20:23], s42 offen offset:544
  buffer_load_dwordx4 v[168:171], v6, s[20:23], s42 offen offset:1088
  buffer_load_dwordx4 v[172:175], v6, s[20:23], s42 offen offset:1632
  s_add_u32 s42, s42, 2176
  v_add_f32 v12, 0x358637bd, v40
  v_rcp_f32 v12, v12
  s_nop 0
  v_pk_mul_f32 v[32:33], v[32:33], v[12:13] op_sel_hi:[1,0]
  v_pk_mul_f32 v[34:35], v[34:35], v[12:13] op_sel_hi:[1,0]
  v_pk_mul_f32 v[36:37], v[36:37], v[12:13] op_sel_hi:[1,0]
  v_pk_mul_f32 v[38:39], v[38:39], v[12:13] op_sel_hi:[1,0]
  v_cvt_pk_bf16_f32 v60, v32, v33
  v_cvt_pk_bf16_f32 v61, v34, v35
  v_cvt_pk_bf16_f32 v62, v36, v37
  v_cvt_pk_bf16_f32 v63, v38, v39
  ds_write_b128 v10, v[60:63] offset:1024
  s_waitcnt vmcnt(12)
  v_cvt_pk_bf16_f32 v112, v112, v113
  v_cvt_pk_bf16_f32 v113, v114, v115
  v_cvt_pk_bf16_f32 v114, v116, v117
  v_cvt_pk_bf16_f32 v115, v118, v119
  v_cvt_pk_bf16_f32 v116, v120, v121
  v_cvt_pk_bf16_f32 v117, v122, v123
  v_cvt_pk_bf16_f32 v118, v124, v125
  v_cvt_pk_bf16_f32 v119, v126, v127
  v_mfma_f32_32x32x16_bf16 v[32:47], v[112:115], v[216:219], 0
  s_nop 0
  v_mfma_f32_32x32x16_bf16 v[32:47], v[116:119], v[220:223], v[32:47]
  buffer_load_dwordx4 v[176:179], v6, s[20:23], s42 offen offset:0
  buffer_load_dwordx4 v[180:183], v6, s[20:23], s42 offen offset:544
  buffer_load_dwordx4 v[184:187], v6, s[20:23], s42 offen offset:1088
  buffer_load_dwordx4 v[188:191], v6, s[20:23], s42 offen offset:1632
  v_add_f32 v12, 0x358637bd, v24
  v_rcp_f32 v12, v12
  s_nop 0
  v_pk_mul_f32 v[16:17], v[16:17], v[12:13] op_sel_hi:[1,0]
  v_pk_mul_f32 v[18:19], v[18:19], v[12:13] op_sel_hi:[1,0]
  v_pk_mul_f32 v[20:21], v[20:21], v[12:13] op_sel_hi:[1,0]
  v_pk_mul_f32 v[22:23], v[22:23], v[12:13] op_sel_hi:[1,0]
  v_cvt_pk_bf16_f32 v56, v16, v17
  v_cvt_pk_bf16_f32 v57, v18, v19
  v_cvt_pk_bf16_f32 v58, v20, v21
  v_cvt_pk_bf16_f32 v59, v22, v23
  ds_write_b128 v10, v[56:59] offset:2048
  s_waitcnt vmcnt(12)
  v_cvt_pk_bf16_f32 v128, v128, v129
  v_cvt_pk_bf16_f32 v129, v130, v131
  v_cvt_pk_bf16_f32 v130, v132, v133
  v_cvt_pk_bf16_f32 v131, v134, v135
  v_cvt_pk_bf16_f32 v132, v136, v137
  v_cvt_pk_bf16_f32 v133, v138, v139
  v_cvt_pk_bf16_f32 v134, v140, v141
  v_cvt_pk_bf16_f32 v135, v142, v143
  v_mfma_f32_32x32x16_bf16 v[16:31], v[128:131], v[224:227], 0
  s_nop 0
  v_mfma_f32_32x32x16_bf16 v[16:31], v[132:135], v[228:231], v[16:31]
  v_add_f32 v12, 0x358637bd, v40
  v_rcp_f32 v12, v12
  s_nop 0
  v_pk_mul_f32 v[32:33], v[32:33], v[12:13] op_sel_hi:[1,0]
  v_pk_mul_f32 v[34:35], v[34:35], v[12:13] op_sel_hi:[1,0]
  v_pk_mul_f32 v[36:37], v[36:37], v[12:13] op_sel_hi:[1,0]
  v_pk_mul_f32 v[38:39], v[38:39], v[12:13] op_sel_hi:[1,0]
  v_cvt_pk_bf16_f32 v60, v32, v33
  v_cvt_pk_bf16_f32 v61, v34, v35
  v_cvt_pk_bf16_f32 v62, v36, v37
  v_cvt_pk_bf16_f32 v63, v38, v39
  ds_write_b128 v10, v[60:63] offset:3072
  s_waitcnt vmcnt(8)
  v_cvt_pk_bf16_f32 v144, v144, v145
  v_cvt_pk_bf16_f32 v145, v146, v147
  v_cvt_pk_bf16_f32 v146, v148, v149
  v_cvt_pk_bf16_f32 v147, v150, v151
  v_cvt_pk_bf16_f32 v148, v152, v153
  v_cvt_pk_bf16_f32 v149, v154, v155
  v_cvt_pk_bf16_f32 v150, v156, v157
  v_cvt_pk_bf16_f32 v151, v158, v159
  v_mfma_f32_32x32x16_bf16 v[32:47], v[144:147], v[232:235], 0
  s_nop 0
  v_mfma_f32_32x32x16_bf16 v[32:47], v[148:151], v[236:239], v[32:47]
  v_add_f32 v12, 0x358637bd, v24
  v_rcp_f32 v12, v12
  s_nop 0
  v_pk_mul_f32 v[16:17], v[16:17], v[12:13] op_sel_hi:[1,0]
  v_pk_mul_f32 v[18:19], v[18:19], v[12:13] op_sel_hi:[1,0]
  v_pk_mul_f32 v[20:21], v[20:21], v[12:13] op_sel_hi:[1,0]
  v_pk_mul_f32 v[22:23], v[22:23], v[12:13] op_sel_hi:[1,0]
  v_cvt_pk_bf16_f32 v56, v16, v17
  v_cvt_pk_bf16_f32 v57, v18, v19
  v_cvt_pk_bf16_f32 v58, v20, v21
  v_cvt_pk_bf16_f32 v59, v22, v23
  ds_write_b128 v10, v[56:59] offset:4096
  s_waitcnt vmcnt(4)
  v_cvt_pk_bf16_f32 v160, v160, v161
  v_cvt_pk_bf16_f32 v161, v162, v163
  v_cvt_pk_bf16_f32 v162, v164, v165
  v_cvt_pk_bf16_f32 v163, v166, v167
  v_cvt_pk_bf16_f32 v164, v168, v169
  v_cvt_pk_bf16_f32 v165, v170, v171
  v_cvt_pk_bf16_f32 v166, v172, v173
  v_cvt_pk_bf16_f32 v167, v174, v175
  v_mfma_f32_32x32x16_bf16 v[16:31], v[160:163], v[240:243], 0
  s_nop 0
  v_mfma_f32_32x32x16_bf16 v[16:31], v[164:167], v[244:247], v[16:31]
  v_add_f32 v12, 0x358637bd, v40
  v_rcp_f32 v12, v12
  s_nop 0
  v_pk_mul_f32 v[32:33], v[32:33], v[12:13] op_sel_hi:[1,0]
  v_pk_mul_f32 v[34:35], v[34:35], v[12:13] op_sel_hi:[1,0]
  v_pk_mul_f32 v[36:37], v[36:37], v[12:13] op_sel_hi:[1,0]
  v_pk_mul_f32 v[38:39], v[38:39], v[12:13] op_sel_hi:[1,0]
  v_cvt_pk_bf16_f32 v60, v32, v33
  v_cvt_pk_bf16_f32 v61, v34, v35
  v_cvt_pk_bf16_f32 v62, v36, v37
  v_cvt_pk_bf16_f32 v63, v38, v39
  ds_write_b128 v10, v[60:63] offset:5120
  s_waitcnt vmcnt(0)
  v_cvt_pk_bf16_f32 v176, v176, v177
  v_cvt_pk_bf16_f32 v177, v178, v179
  v_cvt_pk_bf16_f32 v178, v180, v181
  v_cvt_pk_bf16_f32 v179, v182, v183
  v_cvt_pk_bf16_f32 v180, v184, v185
  v_cvt_pk_bf16_f32 v181, v186, v187
  v_cvt_pk_bf16_f32 v182, v188, v189
  v_cvt_pk_bf16_f32 v183, v190, v191
  v_mfma_f32_32x32x16_bf16 v[32:47], v[176:179], v[248:251], 0
  s_nop 0
  v_mfma_f32_32x32x16_bf16 v[32:47], v[180:183], v[252:255], v[32:47]
  v_add_f32 v12, 0x358637bd, v24
  v_rcp_f32 v12, v12
  s_nop 0
  v_pk_mul_f32 v[16:17], v[16:17], v[12:13] op_sel_hi:[1,0]
  v_pk_mul_f32 v[18:19], v[18:19], v[12:13] op_sel_hi:[1,0]
  v_pk_mul_f32 v[20:21], v[20:21], v[12:13] op_sel_hi:[1,0]
  v_pk_mul_f32 v[22:23], v[22:23], v[12:13] op_sel_hi:[1,0]
  v_cvt_pk_bf16_f32 v56, v16, v17
  v_cvt_pk_bf16_f32 v57, v18, v19
  v_cvt_pk_bf16_f32 v58, v20, v21
  v_cvt_pk_bf16_f32 v59, v22, v23
  ds_write_b128 v10, v[56:59] offset:6144
  v_add_f32 v12, 0x358637bd, v40
  v_rcp_f32 v12, v12
  s_nop 0
  v_pk_mul_f32 v[32:33], v[32:33], v[12:13] op_sel_hi:[1,0]
  v_pk_mul_f32 v[34:35], v[34:35], v[12:13] op_sel_hi:[1,0]
  v_pk_mul_f32 v[36:37], v[36:37], v[12:13] op_sel_hi:[1,0]
  v_pk_mul_f32 v[38:39], v[38:39], v[12:13] op_sel_hi:[1,0]
  v_cvt_pk_bf16_f32 v60, v32, v33
  v_cvt_pk_bf16_f32 v61, v34, v35
  v_cvt_pk_bf16_f32 v62, v36, v37
  v_cvt_pk_bf16_f32 v63, v38, v39
  ds_write_b128 v10, v[60:63] offset:7168
  s_waitcnt lgkmcnt(0)
  s_barrier
  ds_read_b128 v[64:67], v11 offset:0
  ds_read_b128 v[68:71], v11 offset:1024
  ds_read_b128 v[72:75], v11 offset:2048
  ds_read_b128 v[76:79], v11 offset:3072
  ds_read_b128 v[80:83], v11 offset:4096
  ds_read_b128 v[84:87], v11 offset:5120
  s_waitcnt lgkmcnt(5)
  v_mfma_f32_32x32x16_bf16 v[16:31], a[0:3], v[64:67], 0
  ds_read_b128 v[64:67], v11 offset:6144
  s_waitcnt lgkmcnt(5)
  v_mfma_f32_32x32x16_bf16 v[16:31], a[4:7], v[68:71], v[16:31]
  ds_read_b128 v[68:71], v11 offset:7168
  s_waitcnt lgkmcnt(5)
  v_mfma_f32_32x32x16_bf16 v[16:31], a[8:11], v[72:75], v[16:31]
  ds_read_b128 v[72:75], v11 offset:8192
  s_waitcnt lgkmcnt(5)
  v_mfma_f32_32x32x16_bf16 v[16:31], a[12:15], v[76:79], v[16:31]
  ds_read_b128 v[76:79], v11 offset:9216
  s_waitcnt lgkmcnt(5)
  v_mfma_f32_32x32x16_bf16 v[16:31], a[16:19], v[80:83], v[16:31]
  ds_read_b128 v[80:83], v11 offset:10240
  s_waitcnt lgkmcnt(5)
  v_mfma_f32_32x32x16_bf16 v[16:31], a[20:23], v[84:87], v[16:31]
  ds_read_b128 v[84:87], v11 offset:11264
  s_waitcnt lgkmcnt(5)
  v_mfma_f32_32x32x16_bf16 v[16:31], a[24:27], v[64:67], v[16:31]
  ds_read_b128 v[64:67], v11 offset:12288
  s_waitcnt lgkmcnt(5)
  v_mfma_f32_32x32x16_bf16 v[16:31], a[28:31], v[68:71], v[16:31]
  ds_read_b128 v[68:71], v11 offset:13312
  s_waitcnt lgkmcnt(5)
  v_mfma_f32_32x32x16_bf16 v[16:31], a[32:35], v[72:75], v[16:31]
  ds_read_b128 v[72:75], v11 offset:14336
  s_waitcnt lgkmcnt(5)
  v_mfma_f32_32x32x16_bf16 v[16:31], a[36:39], v[76:79], v[16:31]
  ds_read_b128 v[76:79], v11 offset:15360
  s_waitcnt lgkmcnt(5)
  v_mfma_f32_32x32x16_bf16 v[16:31], a[40:43], v[80:83], v[16:31]
  ds_read_b128 v[80:83], v11 offset:16384
  s_waitcnt lgkmcnt(5)
  v_mfma_f32_32x32x16_bf16 v[16:31], a[44:47], v[84:87], v[16:31]
  ds_read_b128 v[84:87], v11 offset:17408
  s_waitcnt lgkmcnt(5)
  v_mfma_f32_32x32x16_bf16 v[16:31], a[48:51], v[64:67], v[16:31]
  ds_read_b128 v[64:67], v11 offset:18432
  s_waitcnt lgkmcnt(5)
  v_mfma_f32_32x32x16_bf16 v[16:31], a[52:55], v[68:71], v[16:31]
  ds_read_b128 v[68:71], v11 offset:19456
  s_waitcnt lgkmcnt(5)
  v_mfma_f32_32x32x16_bf16 v[16:31], a[56:59], v[72:75], v[16:31]
  ds_read_b128 v[72:75], v11 offset:20480
  s_waitcnt lgkmcnt(5)
  v_mfma_f32_32x32x16_bf16 v[16:31], a[60:63], v[76:79], v[16:31]
  ds_read_b128 v[76:79], v11 offset:21504
  s_waitcnt lgkmcnt(5)
  v_mfma_f32_32x32x16_bf16 v[16:31], a[64:67], v[80:83], v[16:31]
  ds_read_b128 v[80:83], v11 offset:22528
  s_waitcnt lgkmcnt(5)
  v_mfma_f32_32x32x16_bf16 v[16:31], a[68:71], v[84:87], v[16:31]
  ds_read_b128 v[84:87], v11 offset:23552
  s_waitcnt lgkmcnt(5)
  v_mfma_f32_32x32x16_bf16 v[16:31], a[72:75], v[64:67], v[16:31]
  ds_read_b128 v[64:67], v11 offset:24576
  s_waitcnt lgkmcnt(5)
  v_mfma_f32_32x32x16_bf16 v[16:31], a[76:79], v[68:71], v[16:31]
  ds_read_b128 v[68:71], v11 offset:25600
  s_waitcnt lgkmcnt(5)
  v_mfma_f32_32x32x16_bf16 v[16:31], a[80:83], v[72:75], v[16:31]
  ds_read_b128 v[72:75], v11 offset:26624
  s_waitcnt lgkmcnt(5)
  v_mfma_f32_32x32x16_bf16 v[16:31], a[84:87], v[76:79], v[16:31]
  ds_read_b128 v[76:79], v11 offset:27648
  s_waitcnt lgkmcnt(5)
  v_mfma_f32_32x32x16_bf16 v[16:31], a[88:91], v[80:83], v[16:31]
  ds_read_b128 v[80:83], v11 offset:28672
  s_waitcnt lgkmcnt(5)
  v_mfma_f32_32x32x16_bf16 v[16:31], a[92:95], v[84:87], v[16:31]
  ds_read_b128 v[84:87], v11 offset:29696
  s_waitcnt lgkmcnt(5)
  v_mfma_f32_32x32x16_bf16 v[16:31], a[96:99], v[64:67], v[16:31]
  ds_read_b128 v[64:67], v11 offset:30720
  s_waitcnt lgkmcnt(5)
  v_mfma_f32_32x32x16_bf16 v[16:31], a[100:103], v[68:71], v[16:31]
  ds_read_b128 v[68:71], v11 offset:31744
  s_waitcnt lgkmcnt(5)
  v_mfma_f32_32x32x16_bf16 v[16:31], a[104:107], v[72:75], v[16:31]
  s_waitcnt lgkmcnt(4)
  v_mfma_f32_32x32x16_bf16 v[16:31], a[108:111], v[76:79], v[16:31]
  s_waitcnt lgkmcnt(3)
  v_mfma_f32_32x32x16_bf16 v[16:31], a[112:115], v[80:83], v[16:31]
  s_waitcnt lgkmcnt(2)
  v_mfma_f32_32x32x16_bf16 v[16:31], a[116:119], v[84:87], v[16:31]
  s_waitcnt lgkmcnt(1)
  v_mfma_f32_32x32x16_bf16 v[16:31], a[120:123], v[64:67], v[16:31]
  s_waitcnt lgkmcnt(0)
  v_mfma_f32_32x32x16_bf16 v[16:31], a[124:127], v[68:71], v[16:31]
  s_mov_b32 s53, 0xffff0000
  s_mov_b32 s52, 0x3f803f80
  s_waitcnt vmcnt(0)
  v_lshlrev_b32 v32, 16, v48
  v_and_b32 v33, s53, v48
  v_lshlrev_b32 v34, 16, v49
  v_and_b32 v35, s53, v49
  v_lshlrev_b32 v36, 16, v50
  v_and_b32 v37, s53, v50
  v_lshlrev_b32 v38, 16, v51
  v_and_b32 v39, s53, v51
  v_lshlrev_b32 v40, 16, v52
  v_and_b32 v41, s53, v52
  v_lshlrev_b32 v42, 16, v53
  v_and_b32 v43, s53, v53
  v_lshlrev_b32 v44, 16, v54
  v_and_b32 v45, s53, v54
  v_lshlrev_b32 v46, 16, v55
  v_and_b32 v47, s53, v55
  v_pk_add_f32 v[16:17], v[16:17], v[32:33]
  v_pk_add_f32 v[18:19], v[18:19], v[34:35]
  v_pk_add_f32 v[20:21], v[20:21], v[36:37]
  v_pk_add_f32 v[22:23], v[22:23], v[38:39]
  v_pk_add_f32 v[24:25], v[24:25], v[40:41]
  v_pk_add_f32 v[26:27], v[26:27], v[42:43]
  v_pk_add_f32 v[28:29], v[28:29], v[44:45]
  v_pk_add_f32 v[30:31], v[30:31], v[46:47]
  v_cvt_pk_bf16_f32 v32, v16, v17
  v_cvt_pk_bf16_f32 v33, v18, v19
  v_cvt_pk_bf16_f32 v34, v20, v21
  v_cvt_pk_bf16_f32 v35, v22, v23
  v_cvt_pk_bf16_f32 v36, v24, v25
  v_cvt_pk_bf16_f32 v37, v26, v27
  v_cvt_pk_bf16_f32 v38, v28, v29
  v_cvt_pk_bf16_f32 v39, v30, v31
  v_permlane32_swap_b32 v32, v34
  v_permlane32_swap_b32 v33, v35
  v_permlane32_swap_b32 v36, v38
  v_permlane32_swap_b32 v37, v39
  s_mov_b32 s24, s16
  s_and_b32 s25, s17, 0xffff
  s_mov_b32 s26, 2097152
  s_mov_b32 s27, 0x20000
  s_lshl_b32 s46, s40, 15
  s_lshl_b32 s47, s44, 6
  s_add_u32 s46, s46, s47
  v_lshlrev_b32 v8, 10, v3
  v_lshl_add_u32 v8, v4, 4, v8
  buffer_store_dwordx4 v[32:35], v8, s[24:27], s46 offen
  buffer_store_dwordx4 v[36:39], v8, s[24:27], s46 offen offset:32
K31_end:
  s_endpgm
.section .rodata,"a"
.p2align 6
.amdhsa_kernel k0_kernel
  .amdhsa_next_free_vgpr 104
  .amdhsa_next_free_sgpr 100
  .amdhsa_accum_offset 104
  .amdhsa_group_segment_fixed_size 0
  .amdhsa_kernarg_size 104
  .amdhsa_user_sgpr_count 2
  .amdhsa_user_sgpr_kernarg_segment_ptr 1
  .amdhsa_system_sgpr_workgroup_id_x 1
.end_amdhsa_kernel
.p2align 6
.amdhsa_kernel k1_kernel
  .amdhsa_next_free_vgpr 160
  .amdhsa_next_free_sgpr 100
  .amdhsa_accum_offset 160
  .amdhsa_group_segment_fixed_size 0
  .amdhsa_kernarg_size 104
  .amdhsa_user_sgpr_count 2
  .amdhsa_user_sgpr_kernarg_segment_ptr 1
  .amdhsa_system_sgpr_workgroup_id_x 1
.end_amdhsa_kernel
.p2align 6
.amdhsa_kernel kf_kernel
  .amdhsa_next_free_vgpr 440
  .amdhsa_next_free_sgpr 100
  .amdhsa_accum_offset 256
  .amdhsa_group_segment_fixed_size 0
  .amdhsa_kernarg_size 104
  .amdhsa_user_sgpr_count 2
  .amdhsa_user_sgpr_kernarg_segment_ptr 1
  .amdhsa_system_sgpr_workgroup_id_x 1
.end_amdhsa_kernel
```
